```python
import torch

def _softmax(x, axis=-1):
    return torch.softmax(x, dim=axis)
def _gelu(x):
    return torch.nn.functional.gelu(x, approximate="tanh")
def _silu(x):
    return torch.nn.functional.silu(x)
def _sigmoid(x):
    return torch.sigmoid(x)
def _layernorm(x, axis=-1, eps=1e-5):
    m = x.mean(dim=axis, keepdim=True)
    v = x.var(dim=axis, keepdim=True, unbiased=False)
    return (x - m) / torch.sqrt(v + eps)
def _scatter_add(tgt, idx, src, axis=0):
    return tgt.clone().index_add_(axis, idx, src)
def _segment_sum(src, seg, n):
    out = torch.zeros((n,) + src.shape[1:], dtype=src.dtype)
    return out.index_add_(0, seg, src)
def _pad(x, pw):
    flat = tuple(v for pair in reversed(pw) for v in pair)
    return torch.nn.functional.pad(x, flat)

kernel_name = 'standalone__attention_interact_autoint__recsys'

def setup_inputs():

    _w = (lambda a: (lambda t: t.to(torch.bfloat16) if t.is_floating_point() else t)(torch.as_tensor(a)))
    B, F = 4096, 100
    D = max(2, (128 // 2) * 2)
    H = 2
    Dh = D // H
    return {
        "e": _w((lambda *s: torch.randn(*s, dtype=torch.bfloat16) * 0.05)(B, F, D).to(float)),
        "wq": _w((lambda *s: torch.randn(*s, dtype=torch.bfloat16) * 1.6)(H, D, Dh).to(float)),
        "wk": _w((lambda *s: torch.randn(*s, dtype=torch.bfloat16) * 1.6)(H, D, Dh).to(float)),
        "wv": _w((lambda *s: torch.randn(*s, dtype=torch.bfloat16) * 0.05)(H, D, Dh).to(float)),
        "wres": _w((lambda *s: torch.randn(*s, dtype=torch.bfloat16) * 0.05)(D, D).to(float)),
    }

def reference(e, wq, wk, wv, wres):
    H, D, Dh = wq.shape[0], wq.shape[1], wq.shape[2]
    B, F = e.shape[0], e.shape[1]
    q = torch.einsum('bfd,hdk->bhfk', e, wq)
    k = torch.einsum('bfd,hdk->bhfk', e, wk)
    v = torch.einsum('bfd,hdk->bhfk', e, wv)
    scale = float(Dh) ** -0.5
    scores = torch.einsum('bhfk,bhgk->bhfg', q, k) * scale
    attn = _softmax(scores, axis=-1)
    attn = (lambda x, dt: x.to(dt))(attn, v.dtype)
    ctx = torch.einsum('bhfg,bhgk->bhfk', attn, v)
    ctx = (lambda x, *d: x.permute(*d))(ctx, 0, 2, 1, 3).reshape(B, F, H * Dh)
    res = torch.einsum('bfd,de->bfe', e, wres)
    out = ctx + res
    mask = (lambda x, dt: x.to(dt))(out > 0, out.dtype)
    return out * mask
```

```asm
; @launch grid=(256,1,1) block=(256,1,1) lds=163840
.amdgcn_target "amdgcn-amd-amdhsa--gfx950"
.text
.globl standalone__attention_interact_autoint__recsys_kernel
.p2align 12
.p2align 8
.type standalone__attention_interact_autoint__recsys_kernel,@function
standalone__attention_interact_autoint__recsys_kernel:
    s_cmp_ge_u32 s2, 256
    s_cbranch_scc1 L_end
    s_load_dwordx8 s[16:23], s[0:1], 0
    s_load_dwordx4 s[24:27], s[0:1], 32
    s_getpc_b64 s[6:7]
    s_bfe_u32 s50, s2, 0x30003
    v_lshrrev_b32 v1, 3, v0
    v_lshl_add_u32 v1, v1, 3, s50
    v_lshlrev_b32 v1, 7, v1
    v_min_u32 v1, L_slow - standalone__attention_interact_autoint__recsys_kernel, v1
    global_load_dword v253, v1, s[6:7]
    s_bfe_u32 s54, s2, 0x40003
    v_and_b32 v102, 0xf0, v0
    v_add_u32 v102, s54, v102
    v_lshlrev_b32 v102, 7, v102
    v_lshrrev_b32 v44, 6, v0
    v_and_b32 v40, 63, v0
    v_readfirstlane_b32 s3, v44
    v_lshrrev_b32 v41, 4, v40
    v_and_b32 v44, 15, v40
    v_xor_b32 v44, v44, v41
    v_lshlrev_b32 v44, 4, v44
    v_lshl_add_u32 v248, v41, 8, v44
    v_lshrrev_b32 v44, 3, v40
    v_and_b32 v46, 2, v44
    v_and_b32 v45, 7, v40
    v_lshlrev_b32 v46, 1, v46
    v_xor_b32 v45, v45, v46
    v_lshlrev_b32 v45, 4, v45
    s_lshl_b32 s50, s3, 10
    v_lshl_add_u32 v98, v44, 7, v45
    s_mov_b32 s30, 32768
    s_mov_b32 s31, 0x20000
    s_add_u32 s37, s50, 0
    s_lshr_b32 s5, s3, 1
    s_lshl_b32 s55, s2, 1
    s_add_u32 s55, s55, s5
    s_mul_i32 s33, s55, 25600
    s_and_b32 s4, s3, 1
    s_mul_i32 s55, s5, 26112
    s_add_u32 s55, s55, 0
    s_mul_i32 s36, s4, 1088
    s_add_u32 s36, s36, s55
    s_lshl_b32 s35, s4, 10
    s_add_u32 s35, s35, s33
    s_add_u32 m0, s36, 0
    s_add_u32 s10, s33, 91776000
    s_mov_b32 s11, 0x20000
    s_mul_i32 s49, s3, 1032
    s_add_u32 s48, s49, 126976
    v_lshl_add_u32 v104, v40, 4, s48
    s_mov_b32 s48, 0xffff0000
    s_mov_b32 s46, 0x3e38aa3b
    s_mov_b32 s47, s46
    s_mul_i32 s56, s5, 4352
    s_mul_i32 s52, s4, 2176
    s_add_u32 s52, s52, s56
    s_mul_i32 s53, s4, 26214400
    s_add_u32 s53, s53, s33
    v_lshl_add_u32 v99, v44, 8, v45
    v_bfe_u32 v43, v40, 2, 2
    v_mul_u32_u24 v46, 1032, v41
    s_mul_i32 s54, s4, 16512
    v_and_b32 v42, 3, v40
    v_lshl_add_u32 v46, v43, 7, v46
    s_add_u32 s54, s54, 60928
    v_and_b32 v45, 2, v43
    v_add_u32 v46, s54, v46
    v_lshl_or_b32 v45, v45, 1, v42
    v_lshl_add_u32 v90, v45, 4, v46
    v_add_u32 v94, 66048, v90
    v_xor_b32 v45, 4, v45
    v_lshl_add_u32 v91, v45, 4, v46
    v_mul_u32_u24 v45, 1088, v43
    s_waitcnt lgkmcnt(0)
    global_load_dword v253, v102, s[20:21]
    global_load_dword v253, v102, s[22:23]
    global_load_dword v253, v102, s[18:19]
    global_load_dword v253, v102, s[24:25]
    s_mov_b32 s28, s20
    s_mov_b32 s29, s21
    buffer_load_dwordx4 v[200:203], v98, s[28:31], s37 offen
    s_addk_i32 s37, 16384
    buffer_load_dwordx4 v[204:207], v98, s[28:31], s37 offen
    s_addk_i32 s37, -12288
    buffer_load_dwordx4 v[208:211], v98, s[28:31], s37 offen
    s_addk_i32 s37, 16384
    buffer_load_dwordx4 v[212:215], v98, s[28:31], s37 offen
    s_addk_i32 s37, -12288
    buffer_load_dwordx4 v[216:219], v98, s[28:31], s37 offen
    s_addk_i32 s37, 16384
    s_mov_b32 s8, s16
    s_mov_b32 s9, s17
    v_lshl_add_u32 v45, v42, 8, v45
    v_xor_b32 v46, v41, v42
    v_lshl_add_u32 v45, v46, 4, v45
    v_add_u32 v245, s55, v45
    v_add_u32 v95, 66048, v91
    s_add_u32 s56, s56, 52224
    v_add_u32 v103, s56, v45
    s_lshl_b32 s51, s3, 11
    s_mov_b32 s41, 0x41800000
    v_and_b32 v45, 15, v40
    buffer_load_dwordx4 v[220:223], v98, s[28:31], s37 offen
    s_addk_i32 s37, -12288
    v_and_b32 v44, 7, v45
    v_lshlrev_b32 v46, 8, v44
    v_and_b32 v47, 8, v45
    v_lshl_add_u32 v46, v47, 3, v46
    v_lshl_add_u32 v46, v41, 4, v46
    s_lshl_b32 s54, s4, 7
    v_add_u32 v246, s54, v46
    s_add_u32 s54, s51, 52224
    v_lshl_add_u32 v105, v40, 2, s54
    v_mov_b32 v190, 0
    s_lshl_b32 s38, s36, 1
    s_add_u32 s57, s51, 121856
    v_lshl_add_u32 v107, v40, 5, s57
    buffer_load_dwordx4 v[224:227], v98, s[28:31], s37 offen
    s_addk_i32 s37, 16384
    v_lshl_add_u32 v46, v43, 4, v41
    v_lshl_add_u32 v46, v46, 2, v42
    v_lshl_add_u32 v250, v46, 2, s57
    v_mul_u32_u24 v46, 264, v41
    v_lshl_add_u32 v46, v43, 4, v46
    v_lshl_add_u32 v46, v42, 1, v46
    v_add_u32 v247, s54, v46
    v_and_b32 v46, 1, v41
    v_lshl_add_u32 v46, v43, 3, v46
    v_and_b32 v47, 1, v42
    v_lshl_add_u32 v46, v46, 3, v47
    buffer_load_dwordx4 v[228:231], v98, s[28:31], s37 offen
    s_add_u32 s37, s35, 0
    s_mov_b32 s28, s22
    s_mov_b32 s29, s23
    v_xor_b32 v47, v41, v42
    v_cmp_gt_u32 vcc, 2, v47
    v_lshl_add_u32 v46, v43, 1, v46
    v_lshl_add_u32 v46, v46, 2, s54
    v_mov_b32 v47, 162880
    v_cndmask_b32 v255, v47, v46, vcc
    v_and_b32 v46, 1, v41
    v_lshl_add_u32 v46, v46, 5, v43
    v_and_b32 v47, 2, v41
    buffer_load_dwordx4 v248, s[8:11], s37 offen nt lds
    s_addk_i32 m0, 128
    v_lshlrev_b32 v46, 5, v46
    v_add_u32 v47, v47, v42
    v_cmp_gt_u32 vcc, 2, v42
    v_lshl_add_u32 v46, v47, 3, v46
    s_add_u32 s54, s57, 24576
    v_add_u32 v46, s54, v46
    v_mov_b32 v47, 162816
    v_cndmask_b32 v254, v47, v46, vcc
    v_and_b32 v46, 1, v43
    v_lshl_add_u32 v46, v46, 1, v42
    v_cmp_gt_u32 vcc, 2, v42
    buffer_load_dwordx4 v248, s[8:11], s37 offen offset:2048 nt lds
    s_addk_i32 m0, 4224
    s_addk_i32 s37, 4096
    v_lshlrev_b32 v45, 5, v45
    v_lshl_add_u32 v46, v41, 4, v46
    v_lshl_add_u32 v45, v41, 3, v45
    v_lshl_add_u32 v46, v46, 5, s57
    v_mov_b32 v47, 146432
    v_add_u32 v251, s57, v45
    v_cndmask_b32 v249, v47, v46, vcc
    v_and_b32 v45, 1, v42
    v_cmp_eq_u32 vcc, 1, v45
    v_mov_b32 v45, 0x44444444
    v_mov_b32 v46, 0xeeeeeeee
    v_cndmask_b32 v244, v45, v46, vcc
    v_lshlrev_b32 v45, 3, v40
    v_mov_b32 v191, 0
    v_add_u32 v45, 162816, v45
    ds_write_b64 v45, v[190:191] offset:0
    ds_write_b64 v45, v[190:191] offset:512
    v_lshl_add_u32 v106, v40, 4, s57
    v_cmp_gt_u32 vcc, 2, v41
    v_mov_b32 v112, 0x3f803f80
    v_mov_b32 v46, 0x40e040e0
    s_lshl_b32 s22, s4, 7
    v_cndmask_b32 v110, v46, v112, vcc
    s_sub_u32 s22, s51, s22
    s_sub_u32 s43, s56, s55
    s_mov_b32 vcc_lo, 0x00ff00ff
    s_mov_b32 s34, 104857600
    s_mov_b32 s32, 0
    s_add_u32 s22, s22, 52224
    s_xor_b32 s7, s51, 2048
    s_add_u32 s38, s38, 69632
    s_add_u32 s43, s43, 8704
    v_mov_b32 v111, 0x3f803f80
    v_mov_b32 v113, 0x3f803f80
    v_mov_b32 v114, 0x3f803f80
    v_mov_b32 v115, 0x3f803f80
    s_mov_b32 vcc_hi, 0x00ff00ff
    v_mov_b32 v252, 0
    s_mov_b32 s12, s26
    s_mov_b32 s13, s27
    s_add_u32 s14, s33, 25600
    s_mov_b32 s15, 0x20000
    s_mov_b32 s40, 0
    s_mov_b32 s42, 0x4e800000
    s_mov_b32 s39, 69632
    s_mov_b32 s20, 0x22221111
    s_mov_b32 s21, 0x88884444
    v_mov_b64 v[172:173], 0
    v_and_b32 v161, -5, v255
    s_add_u32 s6, s51, 53280
    s_add_u32 s7, s7, 53280
    s_add_u32 s32, s32, 1
    s_add_u32 s34, s33, 24576
    buffer_load_dwordx4 v248, s[8:11], s37 offen nt lds
    s_cmp_eq_u32 s3, 0
    s_cbranch_scc1 L_pad0
    s_cmp_eq_u32 s3, 1
    s_cbranch_scc1 L_pad1
    s_cmp_eq_u32 s3, 2
    s_cbranch_scc1 L_pad2
    s_cmp_eq_u32 s3, 3
    s_cbranch_scc1 L_pad6
L_touched:
    s_addk_i32 m0, 128
    s_nop 0
    buffer_load_dwordx4 v248, s[8:11], s37 offen offset:2048 nt lds
    s_add_u32 m0, s49, 93952
    s_add_u32 s37, s50, 0
    s_waitcnt vmcnt(10)
    v_lshlrev_b32 v176, 16, v200
    v_and_b32 v177, s48, v200
    v_lshlrev_b32 v178, 16, v201
    v_and_b32 v179, s48, v201
    v_lshlrev_b32 v180, 16, v202
    v_and_b32 v181, s48, v202
    v_lshlrev_b32 v182, 16, v203
    v_and_b32 v183, s48, v203
    v_lshlrev_b32 v184, 16, v204
    buffer_load_dwordx4 v98, s[28:31], s37 offen lds
    s_addk_i32 m0, 16512
    s_addk_i32 s37, 16384
    v_and_b32 v185, s48, v204
    v_lshlrev_b32 v186, 16, v205
    v_and_b32 v187, s48, v205
    v_lshlrev_b32 v232, 16, v206
    v_and_b32 v233, s48, v206
    v_lshlrev_b32 v234, 16, v207
    v_and_b32 v235, s48, v207
    v_pk_mul_f32 v[176:177], v[176:177], s[46:47]
    v_pk_mul_f32 v[178:179], v[178:179], s[46:47]
    v_pk_mul_f32 v[180:181], v[180:181], s[46:47]
    buffer_load_dwordx4 v98, s[28:31], s37 offen lds
    s_addk_i32 m0, -12384
    s_addk_i32 s37, -12288
    v_pk_mul_f32 v[182:183], v[182:183], s[46:47]
    v_pk_mul_f32 v[184:185], v[184:185], s[46:47]
    v_pk_mul_f32 v[186:187], v[186:187], s[46:47]
    v_pk_mul_f32 v[232:233], v[232:233], s[46:47]
    v_pk_mul_f32 v[234:235], v[234:235], s[46:47]
    v_cvt_pk_bf16_f32 v200, v176, v177
    v_cvt_pk_bf16_f32 v201, v178, v179
    v_cvt_pk_bf16_f32 v202, v180, v181
    v_cvt_pk_bf16_f32 v203, v182, v183
    v_cvt_pk_bf16_f32 v204, v184, v185
    buffer_load_dwordx4 v98, s[28:31], s37 offen lds
    v_cvt_pk_bf16_f32 v205, v186, v187
    v_cvt_pk_bf16_f32 v206, v232, v233
    v_cvt_pk_bf16_f32 v207, v234, v235
    s_addk_i32 m0, 16512
    s_waitcnt vmcnt(11)
    ds_write_b64 v104, v[200:201] offset:0
    ds_write_b64 v104, v[202:203] offset:8
    ds_write_b64 v104, v[204:205] offset:16512
    ds_write_b64 v104, v[206:207] offset:16520
    s_addk_i32 s37, 16384
    v_lshlrev_b32 v176, 16, v208
    v_and_b32 v177, s48, v208
    v_lshlrev_b32 v178, 16, v209
    v_and_b32 v179, s48, v209
    v_lshlrev_b32 v180, 16, v210
    v_and_b32 v181, s48, v210
    v_lshlrev_b32 v182, 16, v211
    v_and_b32 v183, s48, v211
    v_lshlrev_b32 v184, 16, v212
    v_and_b32 v185, s48, v212
    buffer_load_dwordx4 v98, s[28:31], s37 offen lds
    v_lshlrev_b32 v186, 16, v213
    v_and_b32 v187, s48, v213
    v_lshlrev_b32 v232, 16, v214
    v_and_b32 v233, s48, v214
    v_lshlrev_b32 v234, 16, v215
    v_and_b32 v235, s48, v215
    v_pk_mul_f32 v[176:177], v[176:177], s[46:47]
    v_pk_mul_f32 v[178:179], v[178:179], s[46:47]
    v_pk_mul_f32 v[180:181], v[180:181], s[46:47]
    v_pk_mul_f32 v[182:183], v[182:183], s[46:47]
    v_pk_mul_f32 v[184:185], v[184:185], s[46:47]
    v_pk_mul_f32 v[186:187], v[186:187], s[46:47]
    v_pk_mul_f32 v[232:233], v[232:233], s[46:47]
    v_pk_mul_f32 v[234:235], v[234:235], s[46:47]
    v_cvt_pk_bf16_f32 v208, v176, v177
    v_cvt_pk_bf16_f32 v209, v178, v179
    v_cvt_pk_bf16_f32 v210, v180, v181
    v_cvt_pk_bf16_f32 v211, v182, v183
    v_cvt_pk_bf16_f32 v212, v184, v185
    v_cvt_pk_bf16_f32 v213, v186, v187
    v_cvt_pk_bf16_f32 v214, v232, v233
    v_cvt_pk_bf16_f32 v215, v234, v235
    s_waitcnt vmcnt(10)
    s_add_u32 m0, s52, 52224
    ds_write_b64 v104, v[208:209] offset:4128
    ds_write_b64 v104, v[210:211] offset:4136
    ds_write_b64 v104, v[212:213] offset:20640
    ds_write_b64 v104, v[214:215] offset:20648
    v_lshlrev_b32 v176, 16, v216
    s_add_u32 s37, s53, 24576
    v_and_b32 v177, s48, v216
    v_lshlrev_b32 v178, 16, v217
    v_and_b32 v179, s48, v217
    v_lshlrev_b32 v180, 16, v218
    v_and_b32 v181, s48, v218
    v_lshlrev_b32 v182, 16, v219
    v_and_b32 v183, s48, v219
    v_lshlrev_b32 v184, 16, v220
    v_and_b32 v185, s48, v220
    v_lshlrev_b32 v186, 16, v221
    v_and_b32 v187, s48, v221
    buffer_load_dwordx4 v248, s[8:11], s37 offen nt lds
    v_lshlrev_b32 v232, 16, v222
    v_and_b32 v233, s48, v222
    v_lshlrev_b32 v234, 16, v223
    v_and_b32 v235, s48, v223
    v_pk_mul_f32 v[176:177], v[176:177], s[46:47]
    v_pk_mul_f32 v[178:179], v[178:179], s[46:47]
    v_pk_mul_f32 v[180:181], v[180:181], s[46:47]
    v_pk_mul_f32 v[182:183], v[182:183], s[46:47]
    v_pk_mul_f32 v[184:185], v[184:185], s[46:47]
    v_pk_mul_f32 v[186:187], v[186:187], s[46:47]
    v_pk_mul_f32 v[232:233], v[232:233], s[46:47]
    v_pk_mul_f32 v[234:235], v[234:235], s[46:47]
    v_cvt_pk_bf16_f32 v216, v176, v177
    v_cvt_pk_bf16_f32 v217, v178, v179
    v_cvt_pk_bf16_f32 v218, v180, v181
    s_addk_i32 m0, 1088
    v_cvt_pk_bf16_f32 v219, v182, v183
    s_add_u32 s37, s53, 13131776
    v_cvt_pk_bf16_f32 v220, v184, v185
    v_cvt_pk_bf16_f32 v221, v186, v187
    v_cvt_pk_bf16_f32 v222, v232, v233
    v_cvt_pk_bf16_f32 v223, v234, v235
    buffer_load_dwordx4 v248, s[8:11], s37 offen nt lds
    ds_write_b64 v104, v[216:217] offset:8256
    ds_write_b64 v104, v[218:219] offset:8264
    ds_write_b64 v104, v[220:221] offset:24768
    ds_write_b64 v104, v[222:223] offset:24776
    s_waitcnt vmcnt(10)
    v_lshlrev_b32 v176, 16, v224
    v_and_b32 v177, s48, v224
    v_lshlrev_b32 v178, 16, v225
    v_and_b32 v179, s48, v225
    v_lshlrev_b32 v180, 16, v226
    v_and_b32 v181, s48, v226
    v_lshlrev_b32 v182, 16, v227
    v_and_b32 v183, s48, v227
    v_lshlrev_b32 v184, 16, v228
    v_and_b32 v185, s48, v228
    v_lshlrev_b32 v186, 16, v229
    v_and_b32 v187, s48, v229
    v_lshlrev_b32 v232, 16, v230
    v_and_b32 v233, s48, v230
    v_lshlrev_b32 v234, 16, v231
    v_and_b32 v235, s48, v231
    v_pk_mul_f32 v[176:177], v[176:177], s[46:47]
    v_pk_mul_f32 v[178:179], v[178:179], s[46:47]
    v_pk_mul_f32 v[180:181], v[180:181], s[46:47]
    v_pk_mul_f32 v[182:183], v[182:183], s[46:47]
    v_pk_mul_f32 v[184:185], v[184:185], s[46:47]
    v_pk_mul_f32 v[186:187], v[186:187], s[46:47]
    v_pk_mul_f32 v[232:233], v[232:233], s[46:47]
    v_pk_mul_f32 v[234:235], v[234:235], s[46:47]
    v_cvt_pk_bf16_f32 v224, v176, v177
    v_cvt_pk_bf16_f32 v225, v178, v179
    v_cvt_pk_bf16_f32 v226, v180, v181
    v_cvt_pk_bf16_f32 v227, v182, v183
    s_add_u32 m0, s49, 102208
    v_cvt_pk_bf16_f32 v228, v184, v185
    s_add_u32 s37, s50, 8192
    v_cvt_pk_bf16_f32 v229, v186, v187
    v_cvt_pk_bf16_f32 v230, v232, v233
    v_cvt_pk_bf16_f32 v231, v234, v235
    ds_write_b64 v104, v[224:225] offset:12384
    ds_write_b64 v104, v[226:227] offset:12392
    ds_write_b64 v104, v[228:229] offset:28896
    ds_write_b64 v104, v[230:231] offset:28904
    v_bfe_u32 v104, v246, 8, 3
    v_lshl_add_u32 v104, v104, 3, v246
    v_add_u32 v104, s22, v104
    buffer_load_dwordx4 v98, s[28:31], s37 offen lds
    s_addk_i32 m0, 16512
    s_addk_i32 s37, 16384
    s_waitcnt lgkmcnt(0)
    s_barrier
    ds_read_b64_tr_b16 a[0:1], v94 offset:0
    ds_read_b64_tr_b16 a[2:3], v94 offset:512
    ds_read_b64_tr_b16 a[4:5], v94 offset:4128
    ds_read_b64_tr_b16 a[6:7], v94 offset:4640
    ds_read_b64_tr_b16 a[8:9], v94 offset:8256
    ds_read_b64_tr_b16 a[10:11], v94 offset:8768
    ds_read_b64_tr_b16 a[12:13], v94 offset:12384
    ds_read_b64_tr_b16 a[14:15], v94 offset:12896
    ds_read_b64_tr_b16 a[16:17], v94 offset:8
    ds_read_b64_tr_b16 a[18:19], v94 offset:520
    ds_read_b64_tr_b16 a[20:21], v94 offset:4136
    ds_read_b64_tr_b16 a[22:23], v94 offset:4648
    ds_read_b64_tr_b16 a[24:25], v94 offset:8264
    ds_read_b64_tr_b16 a[26:27], v94 offset:8776
    ds_read_b64_tr_b16 a[28:29], v94 offset:12392
    ds_read_b64_tr_b16 a[30:31], v94 offset:12904
    ds_read_b64_tr_b16 a[32:33], v95 offset:0
    ds_read_b64_tr_b16 a[34:35], v95 offset:512
    ds_read_b64_tr_b16 a[36:37], v95 offset:4128
    ds_read_b64_tr_b16 a[38:39], v95 offset:4640
    ds_read_b64_tr_b16 a[40:41], v95 offset:8256
    ds_read_b64_tr_b16 a[42:43], v95 offset:8768
    buffer_load_dwordx4 v98, s[28:31], s37 offen lds
    s_addk_i32 m0, -12384
    s_addk_i32 s37, -12288
    s_waitcnt vmcnt(10)
    s_barrier
    ds_read_b128 v[116:119], v245 offset:0
    ds_read_b128 v[120:123], v245 offset:64
    ds_read_b128 v[124:127], v245 offset:128
    ds_read_b128 v[128:131], v245 offset:192
    ds_read_b64_tr_b16 a[44:45], v95 offset:12384
    ds_read_b64_tr_b16 a[46:47], v95 offset:12896
    s_waitcnt lgkmcnt(15)
    ds_read_b64_tr_b16 a[48:49], v95 offset:8
    ds_read_b64_tr_b16 a[50:51], v95 offset:520
    ds_read_b64_tr_b16 a[52:53], v95 offset:4136
    ds_read_b64_tr_b16 a[54:55], v95 offset:4648
    s_waitcnt lgkmcnt(15)
    ds_read_b64_tr_b16 a[56:57], v95 offset:8264
    ds_read_b64_tr_b16 a[58:59], v95 offset:8776
    ds_read_b64_tr_b16 a[60:61], v95 offset:12392
    ds_read_b64_tr_b16 a[62:63], v95 offset:12904
    buffer_load_dwordx4 v98, s[28:31], s37 offen lds
    s_addk_i32 m0, 16512
    s_addk_i32 s37, 16384
    s_waitcnt lgkmcnt(10)
    v_mfma_f32_16x16x32_bf16 v[232:235], a[0:3], v[116:119], 0
    s_waitcnt lgkmcnt(8)
    v_mfma_f32_16x16x32_bf16 v[232:235], a[4:7], v[120:123], v[232:235]
    v_mfma_f32_16x16x32_bf16 v[232:235], a[8:11], v[124:127], v[232:235]
    v_mfma_f32_16x16x32_bf16 v[232:235], a[12:15], v[128:131], v[232:235]
    s_nop 1
    v_mfma_f32_16x16x32_bf16 v[236:239], a[28:31], v[128:131], 0
    s_nop 2
    v_mfma_f32_16x16x32_bf16 v[236:239], a[24:27], v[124:127], v[236:239]
    s_waitcnt lgkmcnt(0)
    v_cvt_pk_bf16_f32 v0, v232, v233
    v_cvt_pk_bf16_f32 v1, v234, v235
    v_mfma_f32_16x16x32_bf16 v[236:239], a[20:23], v[120:123], v[236:239]
    v_mfma_f32_16x16x32_bf16 v[236:239], a[16:19], v[116:119], v[236:239]
    s_nop 1
    v_mfma_f32_16x16x32_bf16 v[240:243], a[32:35], v[116:119], 0
    s_nop 2
    v_mfma_f32_16x16x32_bf16 v[240:243], a[36:39], v[120:123], v[240:243]
    s_nop 0
    v_cvt_pk_bf16_f32 v2, v236, v237
    v_cvt_pk_bf16_f32 v3, v238, v239
    v_mfma_f32_16x16x32_bf16 v[240:243], a[40:43], v[124:127], v[240:243]
    v_mfma_f32_16x16x32_bf16 v[240:243], a[44:47], v[128:131], v[240:243]
    s_waitcnt vmcnt(9)
    buffer_load_dwordx4 v98, s[28:31], s37 offen lds
    v_mfma_f32_16x16x32_bf16 v[232:235], a[60:63], v[128:131], 0
    s_add_u32 m0, s36, 8704
    s_add_u32 s37, s35, 8192
    s_barrier
    v_mfma_f32_16x16x32_bf16 v[232:235], a[56:59], v[124:127], v[232:235]
    s_mov_b32 s28, s18
    ds_read_b128 v[132:135], v245 offset:4352
    ds_read_b128 v[136:139], v245 offset:4416
    v_mfma_f32_16x16x32_bf16 v[232:235], a[52:55], v[120:123], v[232:235]
    s_mov_b32 s29, s19
    ds_read_b128 v[140:143], v245 offset:4480
    ds_read_b128 v[144:147], v245 offset:4544
    v_mfma_f32_16x16x32_bf16 v[232:235], a[48:51], v[116:119], v[232:235]
    s_mov_b32 s18, 0x00330033
    buffer_load_dwordx4 v248, s[8:11], s37 offen nt lds
    s_addk_i32 m0, 128
    v_cvt_pk_bf16_f32 v4, v240, v241
    v_cvt_pk_bf16_f32 v5, v242, v243
    s_mov_b32 s19, 0x00330033
    s_nop 1
    v_cvt_pk_bf16_f32 v6, v232, v233
    v_cvt_pk_bf16_f32 v7, v234, v235
    buffer_load_dwordx4 v248, s[8:11], s37 offen offset:2048 nt lds
    s_add_u32 m0, s49, 60928
    s_add_u32 s37, s50, 0
    s_waitcnt lgkmcnt(0)
    v_mfma_f32_16x16x32_bf16 v[236:239], a[0:3], v[132:135], 0
    buffer_load_dwordx4 v98, s[28:31], s37 offen lds
    v_mfma_f32_16x16x32_bf16 v[236:239], a[4:7], v[136:139], v[236:239]
    s_addk_i32 m0, 16512
    s_addk_i32 s37, 16384
    v_mfma_f32_16x16x32_bf16 v[236:239], a[8:11], v[140:143], v[236:239]
    v_mfma_f32_16x16x32_bf16 v[236:239], a[12:15], v[144:147], v[236:239]
    s_nop 2
    v_mfma_f32_16x16x32_bf16 v[240:243], a[28:31], v[144:147], 0
    s_nop 0
    buffer_load_dwordx4 v98, s[28:31], s37 offen lds
    v_mfma_f32_16x16x32_bf16 v[240:243], a[24:27], v[140:143], v[240:243]
    s_addk_i32 m0, -12384
    v_cvt_pk_bf16_f32 v8, v236, v237
    v_cvt_pk_bf16_f32 v9, v238, v239
    v_mfma_f32_16x16x32_bf16 v[240:243], a[20:23], v[136:139], v[240:243]
    s_addk_i32 s37, -12288
    v_mfma_f32_16x16x32_bf16 v[240:243], a[16:19], v[132:135], v[240:243]
    s_nop 1
    v_mfma_f32_16x16x32_bf16 v[232:235], a[32:35], v[132:135], 0
    s_nop 2
    v_mfma_f32_16x16x32_bf16 v[232:235], a[36:39], v[136:139], v[232:235]
    s_nop 0
    v_cvt_pk_bf16_f32 v10, v240, v241
    v_cvt_pk_bf16_f32 v11, v242, v243
    v_mfma_f32_16x16x32_bf16 v[232:235], a[40:43], v[140:143], v[232:235]
    v_mfma_f32_16x16x32_bf16 v[232:235], a[44:47], v[144:147], v[232:235]
    s_nop 1
    v_mfma_f32_16x16x32_bf16 v[236:239], a[60:63], v[144:147], 0
    s_branch L_pad0x
.p2align 12
L_pad0:
    s_branch L_touched
L_pad0x:
    s_nop 2
    v_mfma_f32_16x16x32_bf16 v[236:239], a[56:59], v[140:143], v[236:239]
    s_nop 0
    v_cvt_pk_bf16_f32 v12, v232, v233
    v_cvt_pk_bf16_f32 v13, v234, v235
    v_mfma_f32_16x16x32_bf16 v[236:239], a[52:55], v[136:139], v[236:239]
    v_mfma_f32_16x16x32_bf16 v[236:239], a[48:51], v[132:135], v[236:239]
    s_nop 7
    v_cvt_pk_bf16_f32 v14, v236, v237
    v_cvt_pk_bf16_f32 v15, v238, v239
    buffer_load_dwordx4 v98, s[28:31], s37 offen lds
    s_addk_i32 m0, 16512
    s_addk_i32 s37, 16384
    buffer_load_dwordx4 v98, s[28:31], s37 offen lds
    s_add_u32 m0, s36, 13056
    s_add_u32 s37, s35, 12288
    s_cmp_eq_u32 s3, 0
    s_cbranch_scc1 L_pad3
    s_cmp_eq_u32 s3, 1
    s_cbranch_scc1 L_pad4
    s_cmp_eq_u32 s3, 2
    s_cbranch_scc1 L_pad5
L_touched2:
    s_waitcnt vmcnt(10)
    s_barrier
    ds_read_b128 v[200:203], v103 offset:0
    ds_read_b128 v[204:207], v103 offset:64
    ds_read_b128 v[208:211], v103 offset:128
    ds_read_b128 v[212:215], v103 offset:192
    ds_read_b64_tr_b16 a[64:65], v90 offset:33024
    ds_read_b64_tr_b16 a[66:67], v90 offset:33536
    ds_read_b64_tr_b16 a[68:69], v90 offset:37152
    ds_read_b64_tr_b16 a[70:71], v90 offset:37664
    buffer_load_dwordx4 v248, s[8:11], s37 offen nt lds
    s_addk_i32 m0, 128
    ds_read_b64_tr_b16 a[80:81], v90 offset:33032
    ds_read_b64_tr_b16 a[82:83], v90 offset:33544
    ds_read_b64_tr_b16 a[84:85], v90 offset:37160
    ds_read_b64_tr_b16 a[86:87], v90 offset:37672
    ds_read_b64_tr_b16 a[96:97], v91 offset:33024
    ds_read_b64_tr_b16 a[98:99], v91 offset:33536
    ds_read_b64_tr_b16 a[100:101], v91 offset:37152
    buffer_load_dwordx4 v248, s[8:11], s37 offen offset:2048 nt lds
    ds_read_b64_tr_b16 a[102:103], v91 offset:37664
    ds_read_b64_tr_b16 a[112:113], v91 offset:33032
    s_add_u32 m0, s49, 69184
    s_add_u32 s37, s50, 8192
    ds_read_b64_tr_b16 a[114:115], v91 offset:33544
    ds_read_b64_tr_b16 a[116:117], v91 offset:37160
    ds_read_b64_tr_b16 a[118:119], v91 offset:37672
    s_waitcnt lgkmcnt(15)
    v_mfma_f32_16x16x32_bf16 v[240:243], a[0:3], v[200:203], 0
    v_mfma_f32_16x16x32_bf16 v[240:243], a[4:7], v[204:207], v[240:243]
    s_waitcnt lgkmcnt(12)
    buffer_load_dwordx4 v98, s[28:31], s37 offen lds
    v_mfma_f32_16x16x32_bf16 v[240:243], a[8:11], v[208:211], v[240:243]
    s_addk_i32 m0, 16512
    s_addk_i32 s37, 16384
    v_mfma_f32_16x16x32_bf16 v[240:243], a[12:15], v[212:215], v[240:243]
    v_mfma_f32_16x16x32_bf16 v[232:235], a[28:31], v[212:215], 0
    s_waitcnt lgkmcnt(8)
    s_waitcnt vmcnt(9)
    s_barrier
    v_mfma_f32_16x16x32_bf16 v[232:235], a[24:27], v[208:211], v[232:235]
    ds_read_b64_tr_b16 a[72:73], v90 offset:41280
    ds_read_b64_tr_b16 a[74:75], v90 offset:41792
    v_mfma_f32_16x16x32_bf16 v[232:235], a[20:23], v[204:207], v[232:235]
    s_waitcnt lgkmcnt(6)
    ds_read_b64_tr_b16 a[76:77], v90 offset:45408
    ds_read_b64_tr_b16 a[78:79], v90 offset:45920
    v_mfma_f32_16x16x32_bf16 v[232:235], a[16:19], v[200:203], v[232:235]
    ds_read_b64_tr_b16 a[88:89], v90 offset:41288
    ds_read_b64_tr_b16 a[90:91], v90 offset:41800
    v_mfma_f32_16x16x32_bf16 v[236:239], a[32:35], v[200:203], 0
    s_waitcnt lgkmcnt(6)
    ds_read_b64_tr_b16 a[92:93], v90 offset:45416
    ds_read_b64_tr_b16 a[94:95], v90 offset:45928
    v_mfma_f32_16x16x32_bf16 v[236:239], a[36:39], v[204:207], v[236:239]
    v_cvt_pk_bf16_f32 v48, v240, v241
    v_cvt_pk_bf16_f32 v49, v242, v243
    v_mfma_f32_16x16x32_bf16 v[236:239], a[40:43], v[208:211], v[236:239]
    buffer_load_dwordx4 v98, s[28:31], s37 offen lds
    v_mfma_f32_16x16x32_bf16 v[236:239], a[44:47], v[212:215], v[236:239]
    s_addk_i32 m0, -12384
    v_cvt_pk_bf16_f32 v50, v232, v233
    v_cvt_pk_bf16_f32 v51, v234, v235
    v_mfma_f32_16x16x32_bf16 v[240:243], a[60:63], v[212:215], 0
    s_addk_i32 s37, -12288
    ds_read_b64_tr_b16 a[104:105], v91 offset:41280
    ds_read_b64_tr_b16 a[106:107], v91 offset:41792
    v_mfma_f32_16x16x32_bf16 v[240:243], a[56:59], v[208:211], v[240:243]
    ds_read_b64_tr_b16 a[108:109], v91 offset:45408
    ds_read_b64_tr_b16 a[110:111], v91 offset:45920
    v_mfma_f32_16x16x32_bf16 v[240:243], a[52:55], v[204:207], v[240:243]
    ds_read_b64_tr_b16 a[120:121], v91 offset:41288
    ds_read_b64_tr_b16 a[122:123], v91 offset:41800
    v_mfma_f32_16x16x32_bf16 v[240:243], a[48:51], v[200:203], v[240:243]
    ds_read_b64_tr_b16 a[124:125], v91 offset:45416
    ds_read_b64_tr_b16 a[126:127], v91 offset:45928
    v_mfma_f32_16x16x32_bf16 v[232:235], v[116:119], a[64:67], 0
    s_waitcnt lgkmcnt(12)
    v_cvt_pk_bf16_f32 v52, v236, v237
    v_cvt_pk_bf16_f32 v53, v238, v239
    v_mfma_f32_16x16x32_bf16 v[232:235], v[120:123], a[68:71], v[232:235]
    s_nop 0
    v_cvt_pk_bf16_f32 v54, v240, v241
    v_cvt_pk_bf16_f32 v55, v242, v243
    v_mfma_f32_16x16x32_bf16 v[232:235], v[124:127], a[72:75], v[232:235]
    s_waitcnt lgkmcnt(8)
    ds_write_b32 v105, v190 offset:1056
    v_mfma_f32_16x16x32_bf16 v[232:235], v[128:131], a[76:79], v[232:235]
    s_nop 1
    v_mfma_f32_16x16x32_bf16 v[236:239], v[128:131], a[92:95], 0
    s_nop 2
    v_mfma_f32_16x16x32_bf16 v[236:239], v[124:127], a[88:91], v[236:239]
    s_nop 0
    v_cvt_pk_bf16_f32 v56, v232, v233
    v_cvt_pk_bf16_f32 v57, v234, v235
    v_mfma_f32_16x16x32_bf16 v[236:239], v[120:123], a[84:87], v[236:239]
    v_mfma_f32_16x16x32_bf16 v[236:239], v[116:119], a[80:83], v[236:239]
    s_waitcnt lgkmcnt(5)
    s_nop 0
    v_mfma_f32_16x16x32_bf16 v[240:243], v[116:119], a[96:99], 0
    s_nop 2
    v_mfma_f32_16x16x32_bf16 v[240:243], v[120:123], a[100:103], v[240:243]
    s_waitcnt lgkmcnt(1)
    v_cvt_pk_bf16_f32 v60, v236, v237
    v_cvt_pk_bf16_f32 v61, v238, v239
    v_mfma_f32_16x16x32_bf16 v[240:243], v[124:127], a[104:107], v[240:243]
    v_mfma_f32_16x16x32_bf16 v[240:243], v[128:131], a[108:111], v[240:243]
    s_waitcnt lgkmcnt(0)
    s_nop 1
    v_mfma_f32_16x16x32_bf16 v[232:235], v[128:131], a[124:127], 0
    s_nop 0
    buffer_load_dwordx4 v98, s[28:31], s37 offen lds
    v_mfma_f32_16x16x32_bf16 v[232:235], v[124:127], a[120:123], v[232:235]
    s_addk_i32 m0, 16512
    v_cvt_pk_bf16_f32 v64, v240, v241
    v_cvt_pk_bf16_f32 v65, v242, v243
    v_mfma_f32_16x16x32_bf16 v[232:235], v[120:123], a[116:119], v[232:235]
    s_addk_i32 s37, 16384
    v_mfma_f32_16x16x32_bf16 v[232:235], v[116:119], a[112:115], v[232:235]
    s_nop 1
    v_mfma_f32_16x16x32_bf16 v[236:239], v[132:135], a[64:67], 0
    s_nop 2
    v_mfma_f32_16x16x32_bf16 v[236:239], v[136:139], a[68:71], v[236:239]
    s_nop 0
    v_cvt_pk_bf16_f32 v68, v232, v233
    v_cvt_pk_bf16_f32 v69, v234, v235
    v_mfma_f32_16x16x32_bf16 v[236:239], v[140:143], a[72:75], v[236:239]
    v_mfma_f32_16x16x32_bf16 v[236:239], v[144:147], a[76:79], v[236:239]
    s_nop 1
    v_mfma_f32_16x16x32_bf16 v[240:243], v[144:147], a[92:95], 0
    s_nop 2
    v_mfma_f32_16x16x32_bf16 v[240:243], v[140:143], a[88:91], v[240:243]
    s_nop 0
    v_cvt_pk_bf16_f32 v58, v236, v237
    v_cvt_pk_bf16_f32 v59, v238, v239
    v_mfma_f32_16x16x32_bf16 v[240:243], v[136:139], a[84:87], v[240:243]
    v_mfma_f32_16x16x32_bf16 v[240:243], v[132:135], a[80:83], v[240:243]
    s_nop 1
    v_mfma_f32_16x16x32_bf16 v[232:235], v[132:135], a[96:99], 0
    s_nop 2
    v_mfma_f32_16x16x32_bf16 v[232:235], v[136:139], a[100:103], v[232:235]
    s_nop 0
    v_cvt_pk_bf16_f32 v62, v240, v241
    v_cvt_pk_bf16_f32 v63, v242, v243
    v_mfma_f32_16x16x32_bf16 v[232:235], v[140:143], a[104:107], v[232:235]
    s_waitcnt vmcnt(9)
    buffer_load_dwordx4 v98, s[28:31], s37 offen lds
    v_mfma_f32_16x16x32_bf16 v[232:235], v[144:147], a[108:111], v[232:235]
    s_add_u32 m0, s36, 17408
    s_add_u32 s37, s35, 16384
    s_barrier
    v_mfma_f32_16x16x32_bf16 v[236:239], v[144:147], a[124:127], 0
    s_mov_b32 s28, s24
    ds_read_b128 v[116:119], v245 offset:8704
    ds_read_b128 v[120:123], v245 offset:8768
    v_mfma_f32_16x16x32_bf16 v[236:239], v[140:143], a[120:123], v[236:239]
    s_mov_b32 s29, s25
    v_cvt_pk_bf16_f32 v66, v232, v233
    v_cvt_pk_bf16_f32 v67, v234, v235
    v_mfma_f32_16x16x32_bf16 v[236:239], v[136:139], a[116:119], v[236:239]
    s_mov_b32 s24, 4.0
    buffer_load_dwordx4 v248, s[8:11], s37 offen nt lds
    v_mfma_f32_16x16x32_bf16 v[236:239], v[132:135], a[112:115], v[236:239]
    s_addk_i32 m0, 128
    ds_read_b128 v[124:127], v245 offset:8832
    ds_read_b128 v[128:131], v245 offset:8896
    v_mfma_f32_16x16x32_bf16 v[240:243], v[200:203], a[64:67], 0
    s_mov_b32 s25, 0
    ds_write_b128 v107, v[48:51] offset:16384
    v_mfma_f32_16x16x32_bf16 v[240:243], v[204:207], a[68:71], v[240:243]
    buffer_load_dwordx4 v248, s[8:11], s37 offen offset:2048 nt lds
    v_mfma_f32_16x16x32_bf16 v[240:243], v[208:211], a[72:75], v[240:243]
    s_add_u32 m0, s49, 93952
    v_cvt_pk_bf16_f32 v70, v236, v237
    v_cvt_pk_bf16_f32 v71, v238, v239
    v_mfma_f32_16x16x32_bf16 v[240:243], v[212:215], a[76:79], v[240:243]
    s_add_u32 s37, s51, 0
    v_mov_b64 v[148:149], s[24:25]
    v_mov_b64 v[150:151], s[24:25]
    v_mfma_f32_16x16x32_bf16 v[232:235], v[212:215], a[92:95], 0
    ds_write_b128 v107, v[52:55] offset:16400
    v_mfma_f32_16x16x32_bf16 v[232:235], v[208:211], a[88:91], v[232:235]
    buffer_load_dwordx4 v99, s[28:31], s37 offen lds
    v_mfma_f32_16x16x32_bf16 v[232:235], v[204:207], a[84:87], v[232:235]
    s_addk_i32 m0, 16512
    v_mul_f32 v240, s41, v240
    v_mul_f32 v241, s41, v241
    v_mfma_f32_16x16x32_bf16 v[232:235], v[200:203], a[80:83], v[232:235]
    s_addk_i32 s37, 128
    v_mul_f32 v242, s41, v242
    v_mul_f32 v243, s41, v243
    v_mfma_f32_16x16x32_bf16 v[236:239], v[200:203], a[96:99], 0
    s_waitcnt lgkmcnt(2)
    v_cvt_pk_bf16_f32 v176, v240, v241
    v_cvt_pk_bf16_f32 v177, v242, v243
    v_mfma_f32_16x16x32_bf16 v[236:239], v[204:207], a[100:103], v[236:239]
    buffer_load_dwordx4 v99, s[28:31], s37 offen lds
    v_mfma_f32_16x16x32_bf16 v[236:239], v[208:211], a[104:107], v[236:239]
    s_addk_i32 m0, -12384
    v_mul_f32 v232, s41, v232
    v_mul_f32 v233, s41, v233
    v_mfma_f32_16x16x32_bf16 v[236:239], v[212:215], a[108:111], v[236:239]
    s_addk_i32 s37, 8064
    v_mul_f32 v234, s41, v234
    v_mul_f32 v235, s41, v235
    v_mfma_f32_16x16x32_bf16 v[240:243], v[212:215], a[124:127], 0
    v_cvt_pk_bf16_f32 v178, v232, v233
    v_cvt_pk_bf16_f32 v179, v234, v235
    v_mfma_f32_16x16x32_bf16 v[240:243], v[208:211], a[120:123], v[240:243]
    s_nop 0
    v_mul_f32 v236, s41, v236
    v_mul_f32 v237, s41, v237
    v_mfma_f32_16x16x32_bf16 v[240:243], v[204:207], a[116:119], v[240:243]
    v_mul_f32 v238, s41, v238
    v_mul_f32 v239, s41, v239
    v_mfma_f32_16x16x32_bf16 v[240:243], v[200:203], a[112:115], v[240:243]
    s_nop 0
    v_cvt_pk_bf16_f32 v180, v236, v237
    v_cvt_pk_bf16_f32 v181, v238, v239
    v_mfma_f32_16x16x32_bf16 v[232:235], a[0:3], v[116:119], 0
    s_nop 0
    buffer_load_dwordx4 v99, s[28:31], s37 offen lds
    v_mfma_f32_16x16x32_bf16 v[232:235], a[4:7], v[120:123], v[232:235]
    s_addk_i32 m0, 16512
    v_mul_f32 v240, s41, v240
    v_mul_f32 v241, s41, v241
    v_mfma_f32_16x16x32_bf16 v[232:235], a[8:11], v[124:127], v[232:235]
    s_addk_i32 s37, 128
    v_mul_f32 v242, s41, v242
    v_mul_f32 v243, s41, v243
    v_mfma_f32_16x16x32_bf16 v[232:235], a[12:15], v[128:131], v[232:235]
    s_nop 0
    v_cvt_pk_bf16_f32 v182, v240, v241
    v_cvt_pk_bf16_f32 v183, v242, v243
    v_mfma_f32_16x16x32_bf16 v[236:239], a[28:31], v[128:131], 0
    s_nop 0
    ds_write_b128 v107, v[176:179] offset:32768
    v_mfma_f32_16x16x32_bf16 v[236:239], a[24:27], v[124:127], v[236:239]
    s_nop 0
    v_cvt_pk_bf16_f32 v16, v232, v233
    v_cvt_pk_bf16_f32 v17, v234, v235
    v_mfma_f32_16x16x32_bf16 v[236:239], a[20:23], v[120:123], v[236:239]
    v_mov_b64 v[152:153], s[24:25]
    v_mov_b64 v[154:155], s[24:25]
    v_mfma_f32_16x16x32_bf16 v[236:239], a[16:19], v[116:119], v[236:239]
    s_nop 0
    v_mov_b64 v[156:157], s[24:25]
    v_mov_b64 v[158:159], s[24:25]
    v_mfma_f32_16x16x32_bf16 v[240:243], a[32:35], v[116:119], 0
    s_nop 0
    ds_write_b128 v107, v[180:183] offset:32784
    v_mfma_f32_16x16x32_bf16 v[240:243], a[36:39], v[120:123], v[240:243]
    s_nop 0
    v_cvt_pk_bf16_f32 v18, v236, v237
    v_cvt_pk_bf16_f32 v19, v238, v239
    v_mfma_f32_16x16x32_bf16 v[240:243], a[40:43], v[124:127], v[240:243]
    v_mfma_f32_16x16x32_bf16 v[240:243], a[44:47], v[128:131], v[240:243]
    s_nop 0
    buffer_load_dwordx4 v99, s[28:31], s37 offen lds
    v_mfma_f32_16x16x32_bf16 v[232:235], a[60:63], v[128:131], 0
    s_addk_i32 m0, -12384
    s_addk_i32 s37, 8064
    s_waitcnt vmcnt(10)
    v_mfma_f32_16x16x32_bf16 v[232:235], a[56:59], v[124:127], v[232:235]
    s_barrier
    v_cvt_pk_bf16_f32 v20, v240, v241
    v_cvt_pk_bf16_f32 v21, v242, v243
    v_mfma_f32_16x16x32_bf16 v[232:235], a[52:55], v[120:123], v[232:235]
    ds_read_b128 v[132:135], v245 offset:13056
    ds_read_b128 v[136:139], v245 offset:13120
    v_mfma_f32_16x16x32_bf16 v[232:235], a[48:51], v[116:119], v[232:235]
    s_nop 0
    buffer_load_dwordx4 v99, s[28:31], s37 offen lds
    v_mfma_f32_16x16x32_bf16 v[236:239], v[116:119], a[64:67], 0
    s_addk_i32 m0, 16512
    ds_read_b128 v[140:143], v245 offset:13184
    ds_read_b128 v[144:147], v245 offset:13248
    v_mfma_f32_16x16x32_bf16 v[236:239], v[120:123], a[68:71], v[236:239]
    s_addk_i32 s37, 128
    v_cvt_pk_bf16_f32 v22, v232, v233
    v_cvt_pk_bf16_f32 v23, v234, v235
    v_mfma_f32_16x16x32_bf16 v[236:239], v[124:127], a[72:75], v[236:239]
    ds_read_b64_tr_b16 a[128:129], v90 offset:0
    ds_read_b64_tr_b16 a[130:131], v90 offset:512
    v_mfma_f32_16x16x32_bf16 v[236:239], v[128:131], a[76:79], v[236:239]
    s_nop 0
    buffer_load_dwordx4 v99, s[28:31], s37 offen lds
    v_mfma_f32_16x16x32_bf16 v[240:243], v[128:131], a[92:95], 0
    s_addk_i32 m0, -12384
    ds_read_b64_tr_b16 a[132:133], v90 offset:4128
    ds_read_b64_tr_b16 a[134:135], v90 offset:4640
    v_mfma_f32_16x16x32_bf16 v[240:243], v[124:127], a[88:91], v[240:243]
    s_addk_i32 s37, 8064
    v_cvt_pk_bf16_f32 v72, v236, v237
    v_cvt_pk_bf16_f32 v73, v238, v239
    v_mfma_f32_16x16x32_bf16 v[240:243], v[120:123], a[84:87], v[240:243]
    ds_read_b64_tr_b16 a[144:145], v90 offset:8
    ds_read_b64_tr_b16 a[146:147], v90 offset:520
    v_mfma_f32_16x16x32_bf16 v[240:243], v[116:119], a[80:83], v[240:243]
    s_nop 0
    buffer_load_dwordx4 v99, s[28:31], s37 offen lds
    v_mfma_f32_16x16x32_bf16 v[232:235], v[116:119], a[96:99], 0
    s_addk_i32 m0, 16512
    ds_read_b64_tr_b16 a[148:149], v90 offset:4136
    ds_read_b64_tr_b16 a[150:151], v90 offset:4648
    v_mfma_f32_16x16x32_bf16 v[232:235], v[120:123], a[100:103], v[232:235]
    s_addk_i32 s37, 128
    v_cvt_pk_bf16_f32 v76, v240, v241
    v_cvt_pk_bf16_f32 v77, v242, v243
    v_mfma_f32_16x16x32_bf16 v[232:235], v[124:127], a[104:107], v[232:235]
    s_waitcnt lgkmcnt(8)
    ds_read_b64_tr_b16 a[160:161], v91 offset:0
    ds_read_b64_tr_b16 a[162:163], v91 offset:512
    v_mfma_f32_16x16x32_bf16 v[232:235], v[128:131], a[108:111], v[232:235]
    s_nop 0
    buffer_load_dwordx4 v99, s[28:31], s37 offen lds
    v_mfma_f32_16x16x32_bf16 v[236:239], v[128:131], a[124:127], 0
    s_add_u32 m0, s36, 21760
    ds_read_b64_tr_b16 a[164:165], v91 offset:4128
    ds_read_b64_tr_b16 a[166:167], v91 offset:4640
    v_mfma_f32_16x16x32_bf16 v[236:239], v[124:127], a[120:123], v[236:239]
    s_add_u32 s37, s35, 20480
    v_cvt_pk_bf16_f32 v80, v232, v233
    v_cvt_pk_bf16_f32 v81, v234, v235
    v_mfma_f32_16x16x32_bf16 v[236:239], v[120:123], a[116:119], v[236:239]
    s_waitcnt lgkmcnt(8)
    ds_read_b64_tr_b16 a[176:177], v91 offset:8
    ds_read_b64_tr_b16 a[178:179], v91 offset:520
    v_mfma_f32_16x16x32_bf16 v[236:239], v[116:119], a[112:115], v[236:239]
    s_add_u32 s36, s36, 69632
    ds_read_b64_tr_b16 a[180:181], v91 offset:4136
    ds_read_b64_tr_b16 a[182:183], v91 offset:4648
    v_mfma_f32_16x16x32_bf16 v[240:243], a[0:3], v[132:135], 0
    s_add_u32 s35, s35, 13107200
    buffer_load_dwordx4 v248, s[8:11], s37 offen nt lds
    v_mfma_f32_16x16x32_bf16 v[240:243], a[4:7], v[136:139], v[240:243]
    s_addk_i32 m0, 128
    v_cvt_pk_bf16_f32 v84, v236, v237
    v_cvt_pk_bf16_f32 v85, v238, v239
    v_mfma_f32_16x16x32_bf16 v[240:243], a[8:11], v[140:143], v[240:243]
    s_waitcnt lgkmcnt(8)
    v_mfma_f32_16x16x32_bf16 v[240:243], a[12:15], v[144:147], v[240:243]
    s_nop 1
    v_mfma_f32_16x16x32_bf16 v[232:235], a[28:31], v[144:147], 0
    s_nop 2
    v_mfma_f32_16x16x32_bf16 v[232:235], a[24:27], v[140:143], v[232:235]
    s_nop 0
    v_cvt_pk_bf16_f32 v24, v240, v241
    v_cvt_pk_bf16_f32 v25, v242, v243
    v_mfma_f32_16x16x32_bf16 v[232:235], a[20:23], v[136:139], v[232:235]
    s_waitcnt lgkmcnt(4)
    v_mfma_f32_16x16x32_bf16 v[232:235], a[16:19], v[132:135], v[232:235]
    s_nop 1
    v_mfma_f32_16x16x32_bf16 v[236:239], a[32:35], v[132:135], 0
    s_nop 2
    v_mfma_f32_16x16x32_bf16 v[236:239], a[36:39], v[136:139], v[236:239]
    s_waitcnt lgkmcnt(0)
    v_cvt_pk_bf16_f32 v26, v232, v233
    v_cvt_pk_bf16_f32 v27, v234, v235
    v_mfma_f32_16x16x32_bf16 v[236:239], a[40:43], v[140:143], v[236:239]
    v_mfma_f32_16x16x32_bf16 v[236:239], a[44:47], v[144:147], v[236:239]
    s_nop 1
    v_mfma_f32_16x16x32_bf16 v[240:243], a[60:63], v[144:147], 0
    s_nop 2
    v_mfma_f32_16x16x32_bf16 v[240:243], a[56:59], v[140:143], v[240:243]
    s_nop 0
    v_cvt_pk_bf16_f32 v28, v236, v237
    v_cvt_pk_bf16_f32 v29, v238, v239
    v_mfma_f32_16x16x32_bf16 v[240:243], a[52:55], v[136:139], v[240:243]
    s_waitcnt vmcnt(9)
    buffer_load_dwordx4 v248, s[8:11], s37 offen offset:2048 nt lds
    v_mfma_f32_16x16x32_bf16 v[240:243], a[48:51], v[132:135], v[240:243]
    s_barrier
    ds_read_b64_tr_b16 a[136:137], v90 offset:8256
    ds_read_b64_tr_b16 a[138:139], v90 offset:8768
    v_mfma_f32_16x16x32_bf16 v[232:235], v[132:135], a[64:67], 0
    s_mov_b32 m0, s36
    ds_read_b64_tr_b16 a[140:141], v90 offset:12384
    ds_read_b64_tr_b16 a[142:143], v90 offset:12896
    v_mfma_f32_16x16x32_bf16 v[232:235], v[136:139], a[68:71], v[232:235]
    s_mov_b32 s37, s35
    ds_read_b64_tr_b16 a[152:153], v90 offset:8264
    ds_read_b64_tr_b16 a[154:155], v90 offset:8776
    v_mfma_f32_16x16x32_bf16 v[232:235], v[140:143], a[72:75], v[232:235]
    s_add_u32 s35, s35, 13107200
    ds_read_b64_tr_b16 a[156:157], v90 offset:12392
    ds_read_b64_tr_b16 a[158:159], v90 offset:12904
    v_mfma_f32_16x16x32_bf16 v[232:235], v[144:147], a[76:79], v[232:235]
    s_sub_u32 s36, s38, s36
    ds_read_b64_tr_b16 a[168:169], v91 offset:8256
    ds_read_b64_tr_b16 a[170:171], v91 offset:8768
    v_mfma_f32_16x16x32_bf16 v[236:239], v[144:147], a[92:95], 0
    ds_read_b64_tr_b16 a[172:173], v91 offset:12384
    ds_read_b64_tr_b16 a[174:175], v91 offset:12896
    v_mfma_f32_16x16x32_bf16 v[236:239], v[140:143], a[88:91], v[236:239]
    ds_read_b64_tr_b16 a[184:185], v91 offset:8264
    ds_read_b64_tr_b16 a[186:187], v91 offset:8776
    v_mfma_f32_16x16x32_bf16 v[236:239], v[136:139], a[84:87], v[236:239]
    v_cvt_pk_bf16_f32 v30, v240, v241
    v_cvt_pk_bf16_f32 v31, v242, v243
    v_mfma_f32_16x16x32_bf16 v[236:239], v[132:135], a[80:83], v[236:239]
    ds_read_b64_tr_b16 a[188:189], v91 offset:12392
    ds_read_b64_tr_b16 a[190:191], v91 offset:12904
    v_mfma_f32_16x16x32_bf16 v[240:243], v[132:135], a[96:99], 0
    s_nop 0
    v_cvt_pk_bf16_f32 v74, v232, v233
    v_cvt_pk_bf16_f32 v75, v234, v235
    v_mfma_f32_16x16x32_bf16 v[240:243], v[136:139], a[100:103], v[240:243]
    s_nop 0
    v_cvt_pk_bf16_f32 v78, v236, v237
    v_cvt_pk_bf16_f32 v79, v238, v239
    v_mfma_f32_16x16x32_bf16 v[240:243], v[140:143], a[104:107], v[240:243]
    s_waitcnt lgkmcnt(12)
    ds_read_b128 v[116:119], v245 offset:17408
    ds_read_b128 v[120:123], v245 offset:17472
    v_mfma_f32_16x16x32_bf16 v[240:243], v[144:147], a[108:111], v[240:243]
    ds_read_b128 v[124:127], v245 offset:17536
    ds_read_b128 v[128:131], v245 offset:17600
    v_mfma_f32_16x16x32_bf16 v[232:235], v[144:147], a[124:127], 0
    s_waitcnt lgkmcnt(12)
    s_nop 1
    v_mfma_f32_16x16x32_bf16 v[232:235], v[140:143], a[120:123], v[232:235]
    s_nop 0
    v_cvt_pk_bf16_f32 v82, v240, v241
    v_cvt_pk_bf16_f32 v83, v242, v243
    v_mfma_f32_16x16x32_bf16 v[232:235], v[136:139], a[116:119], v[232:235]
    s_waitcnt lgkmcnt(8)
    v_mfma_f32_16x16x32_bf16 v[232:235], v[132:135], a[112:115], v[232:235]
    s_nop 1
    v_mfma_f32_16x16x32_bf16 v[236:239], a[128:131], v[200:203], 0
    s_nop 2
    v_mfma_f32_16x16x32_bf16 v[236:239], a[132:135], v[204:207], v[236:239]
    s_waitcnt lgkmcnt(4)
    v_cvt_pk_bf16_f32 v86, v232, v233
    v_cvt_pk_bf16_f32 v87, v234, v235
    v_mfma_f32_16x16x32_bf16 v[236:239], a[136:139], v[208:211], v[236:239]
    v_mfma_f32_16x16x32_bf16 v[236:239], a[140:143], v[212:215], v[236:239]
    s_nop 1
    v_mfma_f32_16x16x32_bf16 v[240:243], a[156:159], v[212:215], 0
    s_nop 2
    v_mfma_f32_16x16x32_bf16 v[240:243], a[152:155], v[208:211], v[240:243]
    s_waitcnt lgkmcnt(0)
    v_cvt_pk_bf16_f32 v192, v236, v237
    v_cvt_pk_bf16_f32 v194, v238, v239
    v_mfma_f32_16x16x32_bf16 v[240:243], a[148:151], v[204:207], v[240:243]
    v_mfma_f32_16x16x32_bf16 v[240:243], a[144:147], v[200:203], v[240:243]
    s_nop 1
    v_mfma_f32_16x16x32_bf16 v[232:235], a[160:163], v[200:203], 0
    s_nop 2
    v_mfma_f32_16x16x32_bf16 v[232:235], a[164:167], v[204:207], v[232:235]
    s_nop 0
    v_cvt_pk_bf16_f32 v193, v240, v241
    v_cvt_pk_bf16_f32 v195, v242, v243
    v_mfma_f32_16x16x32_bf16 v[232:235], a[168:171], v[208:211], v[232:235]
    ds_write_b128 v107, v[192:195] offset:24576
    v_mfma_f32_16x16x32_bf16 v[232:235], a[172:175], v[212:215], v[232:235]
    v_mfma_f32_16x16x32_bf16 v[236:239], a[188:191], v[212:215], 0
    s_waitcnt vmcnt(2)
    s_barrier
    ds_read_b64_tr_b16 a[192:193], v90 offset:33024
    v_mfma_f32_16x16x32_bf16 v[236:239], a[184:187], v[208:211], v[236:239]
    ds_read_b64_tr_b16 a[194:195], v90 offset:33536
    ds_read_b64_tr_b16 a[196:197], v90 offset:37152
    v_mfma_f32_16x16x32_bf16 v[236:239], a[180:183], v[204:207], v[236:239]
    ds_read_b64_tr_b16 a[198:199], v90 offset:37664
    ds_read_b64_tr_b16 a[200:201], v90 offset:41280
    v_mfma_f32_16x16x32_bf16 v[236:239], a[176:179], v[200:203], v[236:239]
    ds_read_b64_tr_b16 a[202:203], v90 offset:41792
    ds_read_b64_tr_b16 a[204:205], v90 offset:45408
    v_mfma_f32_16x16x32_bf16 v[240:243], a[0:3], v[116:119], 0
    ds_read_b64_tr_b16 a[206:207], v90 offset:45920
    ds_read_b64_tr_b16 a[208:209], v90 offset:33032
    v_mfma_f32_16x16x32_bf16 v[240:243], a[4:7], v[120:123], v[240:243]
    ds_read_b64_tr_b16 a[210:211], v90 offset:33544
    ds_read_b64_tr_b16 a[212:213], v90 offset:37160
    v_mfma_f32_16x16x32_bf16 v[240:243], a[8:11], v[124:127], v[240:243]
    ds_read_b64_tr_b16 a[214:215], v90 offset:37672
    ds_read_b64_tr_b16 a[216:217], v90 offset:41288
    v_mfma_f32_16x16x32_bf16 v[240:243], a[12:15], v[128:131], v[240:243]
    ds_read_b64_tr_b16 a[218:219], v90 offset:41800
    ds_read_b64_tr_b16 a[220:221], v90 offset:45416
    v_cvt_pk_bf16_f32 v196, v232, v233
    ds_read_b64_tr_b16 a[222:223], v90 offset:45928
    ds_read_b64_tr_b16 a[224:225], v91 offset:33024
    v_cvt_pk_bf16_f32 v198, v234, v235
    v_mfma_f32_16x16x32_bf16 v[232:235], a[28:31], v[128:131], 0
    ds_read_b64_tr_b16 a[226:227], v91 offset:33536
    ds_read_b64_tr_b16 a[228:229], v91 offset:37152
    v_mfma_f32_16x16x32_bf16 v[232:235], a[24:27], v[124:127], v[232:235]
    ds_read_b64_tr_b16 a[230:231], v91 offset:37664
    ds_read_b64_tr_b16 a[232:233], v91 offset:41280
    v_mfma_f32_16x16x32_bf16 v[232:235], a[20:23], v[120:123], v[232:235]
    ds_read_b64_tr_b16 a[234:235], v91 offset:41792
    ds_read_b64_tr_b16 a[236:237], v91 offset:45408
    v_mfma_f32_16x16x32_bf16 v[232:235], a[16:19], v[116:119], v[232:235]
    ds_read_b64_tr_b16 a[238:239], v91 offset:45920
    ds_read_b64_tr_b16 a[240:241], v91 offset:33032
    s_waitcnt lgkmcnt(15)
    v_cvt_pk_bf16_f32 v197, v236, v237
    ds_read_b64_tr_b16 a[242:243], v91 offset:33544
    ds_read_b64_tr_b16 a[244:245], v91 offset:37160
    v_cvt_pk_bf16_f32 v199, v238, v239
    v_mfma_f32_16x16x32_bf16 v[236:239], a[32:35], v[116:119], 0
    ds_read_b64_tr_b16 a[246:247], v91 offset:37672
    ds_read_b64_tr_b16 a[248:249], v91 offset:41288
    v_mfma_f32_16x16x32_bf16 v[236:239], a[36:39], v[120:123], v[236:239]
    ds_read_b64_tr_b16 a[250:251], v91 offset:41800
    ds_read_b64_tr_b16 a[252:253], v91 offset:45416
    v_mfma_f32_16x16x32_bf16 v[236:239], a[40:43], v[124:127], v[236:239]
    s_waitcnt lgkmcnt(15)
    ds_read_b64_tr_b16 a[254:255], v91 offset:45928
    v_cvt_pk_bf16_f32 v32, v240, v241
    v_mfma_f32_16x16x32_bf16 v[236:239], a[44:47], v[128:131], v[236:239]
    v_cvt_pk_bf16_f32 v33, v242, v243
    v_cvt_pk_bf16_f32 v34, v232, v233
    v_mfma_f32_16x16x32_bf16 v[240:243], a[60:63], v[128:131], 0
    s_nop 0
    v_cvt_pk_bf16_f32 v35, v234, v235
    s_nop 0
    v_mfma_f32_16x16x32_bf16 v[240:243], a[56:59], v[124:127], v[240:243]
    s_nop 0
    v_cvt_pk_bf16_f32 v36, v236, v237
    v_cvt_pk_bf16_f32 v37, v238, v239
    v_mfma_f32_16x16x32_bf16 v[240:243], a[52:55], v[120:123], v[240:243]
    ds_write_b128 v107, v[196:199] offset:24592
    v_mfma_f32_16x16x32_bf16 v[240:243], a[48:51], v[116:119], v[240:243]
    s_waitcnt lgkmcnt(9)
    ds_read_b128 v[48:51], v249 offset:16384
    ds_read_b128 v[52:55], v249 offset:16400
    v_mfma_f32_16x16x32_bf16 v[216:219], a[192:195], v[200:203], 0
    ds_read2_b64 v[192:195], v254 offset0:0 offset1:64
    ds_read_b64 v[108:109], v251 offset:32768
    v_mfma_f32_16x16x32_bf16 v[216:219], a[196:199], v[204:207], v[216:219]
    s_nop 0
    v_cvt_pk_bf16_f32 v38, v240, v241
    v_cvt_pk_bf16_f32 v39, v242, v243
    v_mfma_f32_16x16x32_bf16 v[216:219], a[200:203], v[208:211], v[216:219]
    s_waitcnt lgkmcnt(5)
    v_add_u32 v254, 128, v254
    v_add_u32 v249, 128, v249
    v_mfma_f32_16x16x32_bf16 v[216:219], a[204:207], v[212:215], v[216:219]
    v_add_u32 v251, 512, v251
    v_mfma_f32_16x16x32_bf16 v[220:223], a[220:223], v[212:215], 0
    v_mfma_f32_16x16x32_bf16 v[220:223], a[216:219], v[208:211], v[220:223]
    v_mfma_f32_16x16x32_bf16 v[220:223], a[212:215], v[204:207], v[220:223]
    v_mfma_f32_16x16x32_bf16 v[220:223], a[208:211], v[200:203], v[220:223]
    s_waitcnt vmcnt(0)
    s_barrier
    ds_read_b128 v[132:135], v245 offset:21760
    v_mfma_f32_16x16x32_bf16 v[224:227], a[224:227], v[200:203], 0
    buffer_load_dwordx4 v248, s[8:11], s37 offen nt lds
    v_mfma_f32_16x16x32_bf16 v[224:227], a[228:231], v[204:207], v[224:227]
    s_addk_i32 m0, 2176
    ds_write_b128 v106, v[216:219] offset:0
    v_mfma_f32_16x16x32_bf16 v[224:227], a[232:235], v[208:211], v[224:227]
    s_addk_i32 s37, 2048
    buffer_load_dwordx4 v248, s[8:11], s37 offen nt lds
    v_mfma_f32_16x16x32_bf16 v[224:227], a[236:239], v[212:215], v[224:227]
    s_addk_i32 m0, 2176
    ds_read_b128 v[136:139], v245 offset:21824
    ds_read_b128 v[140:143], v245 offset:21888
    v_mfma_f32_16x16x32_bf16 v[228:231], a[252:255], v[212:215], 0
    s_addk_i32 s37, 2048
    buffer_load_dwordx4 v248, s[8:11], s37 offen nt lds
    v_mfma_f32_16x16x32_bf16 v[228:231], a[248:251], v[208:211], v[228:231]
    s_addk_i32 m0, 2176
    ds_write_b128 v106, v[220:223] offset:8192
    v_mfma_f32_16x16x32_bf16 v[228:231], a[244:247], v[204:207], v[228:231]
    s_branch L_pad6x
.p2align 12
L_pad6:
    s_branch L_touched
L_pad6x:
    s_addk_i32 s37, 2048
    buffer_load_dwordx4 v248, s[8:11], s37 offen nt lds
    v_mfma_f32_16x16x32_bf16 v[228:231], a[240:243], v[200:203], v[228:231]
    s_addk_i32 m0, 2176
    ds_read_b128 v[144:147], v245 offset:21952
    v_mov_b64 v[200:201], 0
    v_mfma_f32_16x16x32_bf16 v[232:235], v[116:119], a[64:67], 0
    s_addk_i32 s37, 2048
    buffer_load_dwordx4 v248, s[8:11], s37 offen nt lds
    v_mfma_f32_16x16x32_bf16 v[232:235], v[120:123], a[68:71], v[232:235]
    s_addk_i32 m0, 2176
    ds_write_b128 v106, v[224:227] offset:1024
    v_mfma_f32_16x16x32_bf16 v[232:235], v[124:127], a[72:75], v[232:235]
    s_addk_i32 s37, 2048
    buffer_load_dwordx4 v248, s[8:11], s37 offen nt lds
    v_mfma_f32_16x16x32_bf16 v[232:235], v[128:131], a[76:79], v[232:235]
    s_waitcnt lgkmcnt(8)
    v_mov_b64 v[202:203], 0
    v_mov_b64 v[204:205], 0
    v_mfma_f32_16x16x32_bf16 v[236:239], v[128:131], a[92:95], 0
    s_waitcnt lgkmcnt(7)
    v_mov_b64 v[206:207], 0
    v_mov_b32_dpp v196, v192 quad_perm:[2,3,0,1] row_mask:0xf bank_mask:0xf
    v_mfma_f32_16x16x32_bf16 v[236:239], v[124:127], a[88:91], v[236:239]
    s_addk_i32 m0, 2176
    v_cvt_pk_bf16_f32 v88, v232, v233
    v_cvt_pk_bf16_f32 v89, v234, v235
    v_mfma_f32_16x16x32_bf16 v[236:239], v[120:123], a[84:87], v[236:239]
    s_addk_i32 s37, 2048
    ds_write_b128 v106, v[228:231] offset:9216
    v_mfma_f32_16x16x32_bf16 v[236:239], v[116:119], a[80:83], v[236:239]
    s_waitcnt lgkmcnt(2)
    v_mov_b32_dpp v197, v193 quad_perm:[2,3,0,1] row_mask:0xf bank_mask:0xf
    v_mov_b32_dpp v198, v194 quad_perm:[2,3,0,1] row_mask:0xf bank_mask:0xf
    v_mfma_f32_16x16x32_bf16 v[240:243], v[116:119], a[96:99], 0
    v_mov_b32_dpp v199, v195 quad_perm:[2,3,0,1] row_mask:0xf bank_mask:0xf
    s_nop 0
    v_mfma_f32_16x16x32_bf16 v[240:243], v[120:123], a[100:103], v[240:243]
    s_nop 0
    v_cvt_pk_bf16_f32 v92, v236, v237
    v_cvt_pk_bf16_f32 v93, v238, v239
    v_mfma_f32_16x16x32_bf16 v[240:243], v[124:127], a[104:107], v[240:243]
    v_mfma_f32_16x16x32_bf16 v[240:243], v[128:131], a[108:111], v[240:243]
    s_nop 1
    v_mfma_f32_16x16x32_bf16 v[232:235], v[128:131], a[124:127], 0
    s_nop 2
    v_mfma_f32_16x16x32_bf16 v[232:235], v[124:127], a[120:123], v[232:235]
    s_nop 0
    v_cvt_pk_bf16_f32 v96, v240, v241
    v_cvt_pk_bf16_f32 v97, v242, v243
    v_mfma_f32_16x16x32_bf16 v[232:235], v[120:123], a[116:119], v[232:235]
    v_mfma_f32_16x16x32_bf16 v[232:235], v[116:119], a[112:115], v[232:235]
    s_waitcnt lgkmcnt(0)
    s_branch L_mid
.p2align 12
L_pad1:
    s_branch L_touched
L_mid:
    v_smfmac_f32_16x16x64_bf16 v[172:175], v[192:195], v[48:55], v244
    s_nop 1
    ds_read2st64_b32 v[212:213], v250 offset0:0 offset1:32
    v_smfmac_f32_16x16x64_bf16 v[148:151], v[192:195], v[0:7], v244
    s_nop 1
    v_cvt_pk_bf16_f32 v100, v232, v233
    v_smfmac_f32_16x16x64_bf16 v[148:151], v[196:199], v[8:15], v244
    v_cvt_pk_bf16_f32 v101, v234, v235
    v_smfmac_f32_16x16x64_bf16 v[152:155], v[192:195], v[16:23], v244
    s_nop 1
    v_add_f32 v172, v172, v173
    v_smfmac_f32_16x16x64_bf16 v[152:155], v[196:199], v[24:31], v244
    s_nop 1
    v_add_f32 v148, v148, v149
    v_mfma_f32_16x16x32_bf16 v[236:239], a[0:3], v[132:135], 0
    v_exp_f32 v172, v172
    v_mfma_f32_16x16x32_bf16 v[236:239], a[4:7], v[136:139], v[236:239]
    v_cvt_pk_bf16_f32 v173, v172, 0
    v_add_f32 v150, v150, v151
    v_mfma_f32_16x16x32_bf16 v[236:239], a[8:11], v[140:143], v[236:239]
    ds_write_b16 v247, v173 offset:192
    v_mfma_f32_16x16x32_bf16 v[236:239], a[12:15], v[144:147], v[236:239]
    s_nop 0
    v_exp_f32 v148, v148
    v_mfma_f32_16x16x32_bf16 v[240:243], a[28:31], v[144:147], 0
    s_nop 0
    v_exp_f32 v150, v150
    v_mfma_f32_16x16x32_bf16 v[240:243], a[24:27], v[140:143], v[240:243]
    s_nop 0
    ds_read2_b32 v[188:189], v161 offset0:48 offset1:52
    v_cvt_pk_bf16_f32 v40, v236, v237
    v_mfma_f32_16x16x32_bf16 v[240:243], a[20:23], v[136:139], v[240:243]
    v_cvt_pk_bf16_f32 v41, v238, v239
    v_cvt_pk_bf16_f32 v149, v148, v150
    v_mfma_f32_16x16x32_bf16 v[240:243], a[16:19], v[132:135], v[240:243]
    ds_write_b16 v247, v149 offset:0
    v_mfma_f32_16x16x32_bf16 v[232:235], a[32:35], v[132:135], 0
    buffer_load_dwordx4 v248, s[8:11], s37 offen nt lds
    v_mfma_f32_16x16x32_bf16 v[232:235], a[36:39], v[136:139], v[232:235]
    s_addk_i32 m0, 2176
    ds_write_b16_d16_hi v247, v149 offset:8
    v_mfma_f32_16x16x32_bf16 v[232:235], a[40:43], v[140:143], v[232:235]
    s_addk_i32 s37, 2048
    v_cvt_pk_bf16_f32 v42, v240, v241
    v_cvt_pk_bf16_f32 v43, v242, v243
    v_mfma_f32_16x16x32_bf16 v[232:235], a[44:47], v[144:147], v[232:235]
    ds_read2_b32 v[176:177], v255 offset0:0 offset1:2
    ds_read2_b32 v[178:179], v255 offset0:4 offset1:6
    v_mfma_f32_16x16x32_bf16 v[236:239], a[60:63], v[144:147], 0
    s_nop 0
    ds_read2st64_b32 v[214:215], v250 offset0:4 offset1:36
    v_add_f32 v152, v152, v153
    v_mfma_f32_16x16x32_bf16 v[236:239], a[56:59], v[140:143], v[236:239]
    s_nop 0
    v_cvt_pk_bf16_f32 v44, v232, v233
    v_cvt_pk_bf16_f32 v45, v234, v235
    v_mfma_f32_16x16x32_bf16 v[236:239], a[52:55], v[136:139], v[236:239]
    v_add_f32 v154, v154, v155
    v_cndmask_b32 v160, 0, v172, s[18:19]
    v_mfma_f32_16x16x32_bf16 v[236:239], a[48:51], v[132:135], v[236:239]
    s_waitcnt lgkmcnt(5)
    v_cndmask_b32 v188, 0, v188, s[20:21]
    v_cndmask_b32 v189, 0, v189, s[20:21]
    v_mfma_f32_16x16x32_bf16 v[240:243], v[132:135], a[64:67], 0
    s_nop 0
    v_exp_f32 v152, v152
    v_mfma_f32_16x16x32_bf16 v[240:243], v[136:139], a[68:71], v[240:243]
    s_nop 0
    v_cvt_pk_bf16_f32 v46, v236, v237
    v_cvt_pk_bf16_f32 v47, v238, v239
    v_mfma_f32_16x16x32_bf16 v[240:243], v[140:143], a[72:75], v[240:243]
    v_exp_f32 v154, v154
    v_mfma_f32_16x16x32_bf16 v[240:243], v[144:147], a[76:79], v[240:243]
    s_nop 0
    v_cvt_pk_bf16_f32 v153, v152, v154
    v_fma_f32 v160, v160, s41, v148
    v_mfma_f32_16x16x32_bf16 v[232:235], v[144:147], a[92:95], 0
    s_nop 0
    ds_write_b16 v247, v153 offset:64
    v_mfma_f32_16x16x32_bf16 v[232:235], v[140:143], a[88:91], v[232:235]
    s_waitcnt lgkmcnt(2)
    v_cvt_pk_bf16_f32 v90, v240, v241
    v_cvt_pk_bf16_f32 v91, v242, v243
    v_mfma_f32_16x16x32_bf16 v[232:235], v[136:139], a[84:87], v[232:235]
    s_waitcnt lgkmcnt(1)
    ds_write_b16_d16_hi v247, v153 offset:72
    v_mfma_f32_16x16x32_bf16 v[232:235], v[132:135], a[80:83], v[232:235]
    ds_read2_b32 v[180:181], v255 offset0:16 offset1:18
    ds_read2_b32 v[182:183], v255 offset0:20 offset1:22
    v_smfmac_f32_16x16x64_bf16 v[156:159], v[192:195], v[32:39], v244
    s_nop 0
    v_add_f32 v160, v160, v150
    v_smfmac_f32_16x16x64_bf16 v[156:159], v[196:199], v[40:47], v244
    s_nop 1
    v_cvt_pk_bf16_f32 v94, v232, v233
    v_mfma_f32_16x16x32_bf16 v[236:239], v[132:135], a[96:99], 0
    v_cvt_pk_bf16_f32 v95, v234, v235
    v_add_f32 v160, v160, v152
    v_mfma_f32_16x16x32_bf16 v[236:239], v[136:139], a[100:103], v[236:239]
    s_nop 0
    v_add_f32 v156, v156, v157
    v_add_f32 v158, v158, v159
    v_mfma_f32_16x16x32_bf16 v[236:239], v[140:143], a[104:107], v[236:239]
    v_exp_f32 v156, v156
    v_mfma_f32_16x16x32_bf16 v[236:239], v[144:147], a[108:111], v[236:239]
    v_exp_f32 v158, v158
    v_mfma_f32_16x16x32_bf16 v[240:243], v[144:147], a[124:127], 0
    v_cvt_pk_bf16_f32 v157, v156, v158
    v_add_f32 v160, v160, v154
    v_mfma_f32_16x16x32_bf16 v[240:243], v[140:143], a[120:123], v[240:243]
    ds_write_b16 v247, v157 offset:128
    v_mfma_f32_16x16x32_bf16 v[240:243], v[136:139], a[116:119], v[240:243]
    ds_write_b16_d16_hi v247, v157 offset:136
    v_mfma_f32_16x16x32_bf16 v[240:243], v[132:135], a[112:115], v[240:243]
    s_waitcnt lgkmcnt(2)
    ds_read2_b32 v[184:185], v255 offset0:32 offset1:34
    ds_read2_b32 v[186:187], v255 offset0:36 offset1:38
    v_mfma_f32_16x16x32_bf16 v[208:211], v[188:191], v[108:111], 0
    v_cvt_pk_bf16_f32 v98, v236, v237
    v_cvt_pk_bf16_f32 v99, v238, v239
    v_smfmac_f32_16x16x64_bf16 v[200:203], v[176:179], v[56:63], v244
    s_nop 0
    v_cvt_pk_bf16_f32 v102, v240, v241
    v_smfmac_f32_16x16x64_bf16 v[204:207], v[176:179], v[64:71], v244
    v_cvt_pk_bf16_f32 v103, v242, v243
    v_mfma_f32_16x16x32_bf16 v[232:235], a[128:131], v[116:119], 0
    buffer_load_dwordx4 v248, s[8:11], s37 offen nt lds
    v_mfma_f32_16x16x32_bf16 v[232:235], a[132:135], v[120:123], v[232:235]
    s_addk_i32 m0, 2176
    v_add_f32 v160, v160, v156
    v_add_f32 v160, v160, v158
    v_mfma_f32_16x16x32_bf16 v[232:235], a[136:139], v[124:127], v[232:235]
    s_addk_i32 s37, 2048
    v_add_f32_dpp v160, v160, v160 row_ror:8 row_mask:0xf bank_mask:0xf
    v_add_u32 v250, 64, v250
    v_mfma_f32_16x16x32_bf16 v[232:235], a[140:143], v[128:131], v[232:235]
    v_add_f32_dpp v160, v160, v160 row_ror:4 row_mask:0xf bank_mask:0xf
    s_nop 0
    v_mfma_f32_16x16x32_bf16 v[236:239], a[156:159], v[128:131], 0
    s_nop 0
    v_add_f32_dpp v160, v160, v160 row_ror:2 row_mask:0xf bank_mask:0xf
    s_nop 0
    v_mfma_f32_16x16x32_bf16 v[236:239], a[152:155], v[124:127], v[236:239]
    s_nop 0
    v_cvt_pk_bf16_f32 v192, v232, v233
    v_cvt_pk_bf16_f32 v193, v234, v235
    v_mfma_f32_16x16x32_bf16 v[236:239], a[148:151], v[120:123], v[236:239]
    s_waitcnt lgkmcnt(0)
    v_add_f32_dpp v160, v160, v160 row_ror:1 row_mask:0xf bank_mask:0xf
    v_mfma_f32_16x16x32_bf16 v[236:239], a[144:147], v[116:119], v[236:239]
    v_rcp_f32 v253, v160
    v_smfmac_f32_16x16x64_bf16 v[200:203], v[180:183], v[72:79], v244
    s_nop 1
    v_maximum3_f32 v252, v252, v160, v253
    v_smfmac_f32_16x16x64_bf16 v[204:207], v[180:183], v[80:87], v244
    s_nop 1
    v_cvt_pk_bf16_f32 v194, v236, v237
    v_smfmac_f32_16x16x64_bf16 v[200:203], v[184:187], v[88:95], v244
    s_nop 0
    v_cvt_pk_bf16_f32 v195, v238, v239
    v_smfmac_f32_16x16x64_bf16 v[204:207], v[184:187], v[96:103], v244
    s_nop 2
    v_mfma_f32_16x16x32_bf16 v[240:243], a[160:163], v[116:119], 0
    s_nop 0
    v_add_f32 v200, v200, v201
    v_add_f32 v202, v202, v203
    v_mfma_f32_16x16x32_bf16 v[240:243], a[164:167], v[120:123], v[240:243]
    v_add_f32 v204, v204, v205
    v_add_f32 v206, v206, v207
    v_mfma_f32_16x16x32_bf16 v[240:243], a[168:171], v[124:127], v[240:243]
    v_add_f32 v208, v208, v200
    v_add_f32 v209, v209, v202
    v_mfma_f32_16x16x32_bf16 v[240:243], a[172:175], v[128:131], v[240:243]
    v_add_f32 v210, v210, v204
    v_add_f32 v211, v211, v206
    v_mfma_f32_16x16x32_bf16 v[232:235], a[188:191], v[128:131], 0
    s_nop 0
    v_fma_f32 v208, v208, v253, v212
    v_fma_f32 v209, v209, v253, v213
    v_mfma_f32_16x16x32_bf16 v[232:235], a[184:187], v[124:127], v[232:235]
    s_nop 0
    v_cvt_pk_bf16_f32 v196, v240, v241
    v_cvt_pk_bf16_f32 v197, v242, v243
    v_mfma_f32_16x16x32_bf16 v[232:235], a[180:183], v[120:123], v[232:235]
    v_fma_f32 v210, v210, v253, v214
    v_fma_f32 v211, v211, v253, v215
    v_mfma_f32_16x16x32_bf16 v[232:235], a[176:179], v[116:119], v[232:235]
    v_cvt_pk_bf16_f32 v208, v208, v209
    v_cvt_pk_bf16_f32 v210, v210, v211
    v_mfma_f32_16x16x32_bf16 v[216:219], a[192:195], v[116:119], 0
    s_nop 0
    v_pk_max_i16 v208, v208, 0
    v_pk_max_i16 v210, v210, 0
    v_mfma_f32_16x16x32_bf16 v[216:219], a[196:199], v[120:123], v[216:219]
    s_nop 0
    v_cvt_pk_bf16_f32 v198, v232, v233
    v_cvt_pk_bf16_f32 v199, v234, v235
    v_mfma_f32_16x16x32_bf16 v[216:219], a[200:203], v[124:127], v[216:219]
    ds_write_b16 v247, v208 offset:0
    v_mfma_f32_16x16x32_bf16 v[216:219], a[204:207], v[128:131], v[216:219]
    ds_write_b16 v247, v210 offset:64
    v_mfma_f32_16x16x32_bf16 v[172:175], v[48:51], v[192:195], 0
    ds_write_b16_d16_hi v247, v208 offset:8
    v_mfma_f32_16x16x32_bf16 v[172:175], v[52:55], v[196:199], v[172:175]
    ds_write_b16_d16_hi v247, v210 offset:72
    v_mfma_f32_16x16x32_bf16 v[148:151], v[4:7], v[196:199], 4.0
    ds_read2_b64 v[104:107], v104 offset0:0 offset1:1
    v_mfma_f32_16x16x32_bf16 v[148:151], v[0:3], v[192:195], v[148:151]
    s_nop 0
    buffer_load_dwordx4 v248, s[8:11], s37 offen nt lds
    v_mfma_f32_16x16x32_bf16 v[152:155], v[8:11], v[192:195], 4.0
    s_addk_i32 m0, 2176
    v_exp_f32 v172, v172
    v_mfma_f32_16x16x32_bf16 v[152:155], v[12:15], v[196:199], v[152:155]
    s_addk_i32 s37, 2048
    v_exp_f32 v173, v173
    v_mfma_f32_16x16x32_bf16 v[156:159], v[20:23], v[196:199], 4.0
    v_cvt_pk_bf16_f32 v188, v172, v173
    v_cvt_pk_bf16_f32 v189, v172, v173
    v_mfma_f32_16x16x32_bf16 v[156:159], v[16:19], v[192:195], v[156:159]
    s_nop 0
    v_permlane16_swap_b32 v188, v189
    v_mfma_f32_16x16x32_bf16 v[160:163], v[24:27], v[192:195], 4.0
    v_exp_f32 v148, v148
    v_mfma_f32_16x16x32_bf16 v[160:163], v[28:31], v[196:199], v[160:163]
    v_exp_f32 v149, v149
    v_mfma_f32_16x16x32_bf16 v[164:167], v[36:39], v[196:199], 4.0
    v_exp_f32 v150, v150
    v_mfma_f32_16x16x32_bf16 v[164:167], v[32:35], v[192:195], v[164:167]
    v_exp_f32 v151, v151
    v_mfma_f32_16x16x32_bf16 v[168:171], v[40:43], v[192:195], 4.0
    s_waitcnt lgkmcnt(0)
    v_exp_f32 v152, v152
    v_mfma_f32_16x16x32_bf16 v[168:171], v[44:47], v[196:199], v[168:171]
    v_exp_f32 v153, v153
    v_mfma_f32_16x16x32_bf16 v[220:223], a[220:223], v[128:131], 0
    v_exp_f32 v154, v154
    v_mfma_f32_16x16x32_bf16 v[220:223], a[216:219], v[124:127], v[220:223]
    v_exp_f32 v155, v155
    v_mfma_f32_16x16x32_bf16 v[220:223], a[212:215], v[120:123], v[220:223]
    v_exp_f32 v156, v156
    v_mfma_f32_16x16x32_bf16 v[220:223], a[208:211], v[116:119], v[220:223]
    v_exp_f32 v157, v157
    v_mfma_f32_16x16x32_bf16 v[224:227], a[224:227], v[116:119], 0
    v_exp_f32 v158, v158
    v_mfma_f32_16x16x32_bf16 v[224:227], a[228:231], v[120:123], v[224:227]
    v_exp_f32 v159, v159
    v_mfma_f32_16x16x32_bf16 v[224:227], a[232:235], v[124:127], v[224:227]
    v_exp_f32 v160, v160
    v_mfma_f32_16x16x32_bf16 v[224:227], a[236:239], v[128:131], v[224:227]
    v_exp_f32 v161, v161
    v_mfma_f32_16x16x32_bf16 v[228:231], a[252:255], v[128:131], 0
    v_exp_f32 v162, v162
    v_mfma_f32_16x16x32_bf16 v[228:231], a[248:251], v[124:127], v[228:231]
    v_exp_f32 v163, v163
    v_mfma_f32_16x16x32_bf16 v[228:231], a[244:247], v[120:123], v[228:231]
    v_cvt_pk_bf16_f32 v176, v148, v149
    v_cvt_pk_bf16_f32 v177, v150, v151
    v_mfma_f32_16x16x32_bf16 v[228:231], a[240:243], v[116:119], v[228:231]
    v_cvt_pk_bf16_f32 v178, v152, v153
    v_cvt_pk_bf16_f32 v179, v154, v155
    v_mfma_f32_16x16x32_bf16 v[236:239], a[128:131], v[132:135], 0
    v_cvt_pk_bf16_f32 v180, v156, v157
    v_cvt_pk_bf16_f32 v181, v158, v159
    v_mfma_f32_16x16x32_bf16 v[236:239], a[132:135], v[136:139], v[236:239]
    v_cvt_pk_bf16_f32 v182, v160, v161
    v_cvt_pk_bf16_f32 v183, v162, v163
    v_mfma_f32_16x16x32_bf16 v[236:239], a[136:139], v[140:143], v[236:239]
    v_exp_f32 v164, v164
    v_mfma_f32_16x16x32_bf16 v[236:239], a[140:143], v[144:147], v[236:239]
    v_exp_f32 v165, v165
    v_mfma_f32_16x16x32_bf16 v[240:243], a[156:159], v[144:147], 0
    v_exp_f32 v166, v166
    v_mfma_f32_16x16x32_bf16 v[240:243], a[152:155], v[140:143], v[240:243]
    s_nop 0
    buffer_load_dwordx4 v248, s[8:11], s37 offen nt lds
    v_mfma_f32_16x16x32_bf16 v[240:243], a[148:151], v[136:139], v[240:243]
    s_addk_i32 m0, 2176
    v_cvt_pk_bf16_f32 v192, v236, v237
    v_cvt_pk_bf16_f32 v193, v238, v239
    v_mfma_f32_16x16x32_bf16 v[240:243], a[144:147], v[132:135], v[240:243]
    s_addk_i32 s37, 2048
    v_exp_f32 v167, v167
    v_mfma_f32_16x16x32_bf16 v[232:235], a[160:163], v[132:135], 0
    v_exp_f32 v168, v168
    v_mfma_f32_16x16x32_bf16 v[232:235], a[164:167], v[136:139], v[232:235]
    v_exp_f32 v169, v169
    v_mfma_f32_16x16x32_bf16 v[232:235], a[168:171], v[140:143], v[232:235]
    v_exp_f32 v170, v170
    v_mfma_f32_16x16x32_bf16 v[232:235], a[172:175], v[144:147], v[232:235]
    v_exp_f32 v171, v171
    v_mfma_f32_16x16x32_bf16 v[236:239], a[188:191], v[144:147], 0
    v_cvt_pk_bf16_f32 v184, v164, v165
    v_cvt_pk_bf16_f32 v185, v166, v167
    v_mfma_f32_16x16x32_bf16 v[236:239], a[184:187], v[140:143], v[236:239]
    v_cvt_pk_bf16_f32 v186, v168, v169
    v_cvt_pk_bf16_f32 v187, v170, v171
    v_mfma_f32_16x16x32_bf16 v[236:239], a[180:183], v[136:139], v[236:239]
    v_cvt_pk_bf16_f32 v194, v240, v241
    v_cvt_pk_bf16_f32 v195, v242, v243
    v_mfma_f32_16x16x32_bf16 v[236:239], a[176:179], v[132:135], v[236:239]
    buffer_store_dwordx4 v[104:107], v246, s[12:15], s34 offen sc0 sc1
    v_cvt_pk_bf16_f32 v196, v232, v233
    v_mfma_f32_16x16x4_4b_bf16 v[200:215], v[108:109], v[188:189], 0
    v_cvt_pk_bf16_f32 v197, v234, v235
    s_add_u32 s34, s33, 16384
    v_smfmac_f32_16x16x64_bf16 v[172:175], v[112:115], v[176:183], v244
    s_nop 1
    v_cvt_pk_bf16_f32 v198, v236, v237
    v_smfmac_f32_16x16x64_bf16 v[172:175], v[110:113], v[184:191], v244
    s_nop 1
    v_cvt_pk_bf16_f32 v199, v238, v239
    v_mfma_f32_16x16x32_bf16 v[200:203], v[56:59], v[176:179], v[200:203]
    ds_read_b128 v[116:119], v245 offset:13056
    ds_read_b128 v[120:123], v245 offset:13120
    v_mfma_f32_16x16x32_bf16 v[200:203], v[72:75], v[180:183], v[200:203]
    ds_read_b128 v[124:127], v245 offset:13184
    v_add_f32 v174, v174, v175
    v_mfma_f32_16x16x32_bf16 v[200:203], v[88:91], v[184:187], v[200:203]
    s_nop 0
    v_rcp_f32 v253, v174
    v_mfma_f32_16x16x32_bf16 v[204:207], v[92:95], v[184:187], v[204:207]
    s_nop 0
    ds_read_b128 v[128:131], v245 offset:13248
    v_maximum3_f32 v252, v252, v174, v253
    v_mfma_f32_16x16x32_bf16 v[204:207], v[76:79], v[180:183], v[204:207]
    s_nop 0
    v_fma_f32 v200, v200, v253, v216
    v_fma_f32 v201, v201, v253, v217
    v_mfma_f32_16x16x32_bf16 v[204:207], v[60:63], v[176:179], v[204:207]
    v_fma_f32 v202, v202, v253, v218
    v_fma_f32 v203, v203, v253, v219
    v_mfma_f32_16x16x32_bf16 v[208:211], v[64:67], v[176:179], v[208:211]
    s_nop 0
    v_cvt_pk_bf16_f32 v200, v200, v201
    v_cvt_pk_bf16_f32 v201, v202, v203
    v_mfma_f32_16x16x32_bf16 v[208:211], v[80:83], v[180:183], v[208:211]
    s_nop 0
    v_fma_f32 v204, v204, v253, v220
    v_fma_f32 v205, v205, v253, v221
    v_mfma_f32_16x16x32_bf16 v[208:211], v[96:99], v[184:187], v[208:211]
    v_fma_f32 v206, v206, v253, v222
    v_fma_f32 v207, v207, v253, v223
    v_mfma_f32_16x16x32_bf16 v[212:215], v[100:103], v[184:187], v[212:215]
    s_nop 0
    v_cvt_pk_bf16_f32 v202, v204, v205
    v_cvt_pk_bf16_f32 v203, v206, v207
    v_mfma_f32_16x16x32_bf16 v[212:215], v[84:87], v[180:183], v[212:215]
    s_nop 0
    v_fma_f32 v208, v208, v253, v224
    v_fma_f32 v209, v209, v253, v225
    v_mfma_f32_16x16x32_bf16 v[212:215], v[68:71], v[176:179], v[212:215]
    v_fma_f32 v210, v210, v253, v226
    v_fma_f32 v211, v211, v253, v227
    v_mfma_f32_16x16x32_bf16 v[172:175], v[48:51], v[192:195], 0
    s_waitcnt lgkmcnt(0)
    v_cvt_pk_bf16_f32 v104, v208, v209
    v_cvt_pk_bf16_f32 v105, v210, v211
    v_mfma_f32_16x16x32_bf16 v[172:175], v[52:55], v[196:199], v[172:175]
    buffer_load_dwordx4 v248, s[8:11], s37 offen nt lds
    v_mfma_f32_16x16x32_bf16 v[148:151], v[4:7], v[196:199], 4.0
    s_addk_i32 m0, 2176
    v_fma_f32 v212, v212, v253, v228
    v_fma_f32 v213, v213, v253, v229
    v_mfma_f32_16x16x32_bf16 v[148:151], v[0:3], v[192:195], v[148:151]
    s_addk_i32 s37, 2048
    v_fma_f32 v214, v214, v253, v230
    v_fma_f32 v215, v215, v253, v231
    v_mfma_f32_16x16x32_bf16 v[152:155], v[8:11], v[192:195], 4.0
    v_exp_f32 v172, v172
    v_mfma_f32_16x16x32_bf16 v[152:155], v[12:15], v[196:199], v[152:155]
    v_exp_f32 v173, v173
    v_mfma_f32_16x16x32_bf16 v[156:159], v[20:23], v[196:199], 4.0
    v_cvt_pk_bf16_f32 v106, v212, v213
    v_cvt_pk_bf16_f32 v107, v214, v215
    v_mfma_f32_16x16x32_bf16 v[156:159], v[16:19], v[192:195], v[156:159]
    v_cvt_pk_bf16_f32 v188, v172, v173
    v_cvt_pk_bf16_f32 v189, v172, v173
    v_mfma_f32_16x16x32_bf16 v[160:163], v[24:27], v[192:195], 4.0
    v_cndmask_b32_dpp v204, v104, v200, vcc row_ror:8 row_mask:0xf bank_mask:0xf
    v_cndmask_b32_dpp v205, v105, v201, vcc row_ror:8 row_mask:0xf bank_mask:0xf
    v_mfma_f32_16x16x32_bf16 v[160:163], v[28:31], v[196:199], v[160:163]
    v_cndmask_b32_dpp v206, v106, v202, vcc row_ror:8 row_mask:0xf bank_mask:0xf
    v_cndmask_b32_dpp v207, v107, v203, vcc row_ror:8 row_mask:0xf bank_mask:0xf
    v_mfma_f32_16x16x32_bf16 v[164:167], v[36:39], v[196:199], 4.0
    v_pk_max_i16 v204, v204, 0
    v_pk_max_i16 v205, v205, 0
    v_mfma_f32_16x16x32_bf16 v[164:167], v[32:35], v[192:195], v[164:167]
    v_pk_max_i16 v206, v206, 0
    v_pk_max_i16 v207, v207, 0
    v_mfma_f32_16x16x32_bf16 v[168:171], v[40:43], v[192:195], 4.0
    v_mov_b32_dpp v104, v200 row_ror:8 row_mask:0xf bank_mask:0x3
    v_mov_b32_dpp v105, v201 row_ror:8 row_mask:0xf bank_mask:0x3
    v_mfma_f32_16x16x32_bf16 v[168:171], v[44:47], v[196:199], v[168:171]
    v_mov_b32_dpp v106, v202 row_ror:8 row_mask:0xf bank_mask:0x3
    v_mov_b32_dpp v107, v203 row_ror:8 row_mask:0xf bank_mask:0x3
    v_mfma_f32_16x16x32_bf16 v[216:219], a[192:195], v[132:135], 0
    buffer_store_dwordx4 v[204:207], v246, s[12:15], s34 offen offset:0 sc0 sc1
    v_permlane16_swap_b32 v188, v189
    v_pk_max_i16 v104, v104, 0
    v_mfma_f32_16x16x32_bf16 v[216:219], a[196:199], v[136:139], v[216:219]
    v_pk_max_i16 v105, v105, 0
    v_pk_max_i16 v106, v106, 0
    v_mfma_f32_16x16x32_bf16 v[216:219], a[200:203], v[140:143], v[216:219]
    v_exp_f32 v148, v148
    v_mfma_f32_16x16x32_bf16 v[216:219], a[204:207], v[144:147], v[216:219]
    v_exp_f32 v149, v149
    v_mfma_f32_16x16x32_bf16 v[220:223], a[220:223], v[144:147], 0
    v_pk_max_i16 v107, v107, 0
    v_cvt_pk_bf16_f32 v176, v148, v149
    v_mfma_f32_16x16x32_bf16 v[220:223], a[216:219], v[140:143], v[220:223]
    v_exp_f32 v150, v150
    v_mfma_f32_16x16x32_bf16 v[220:223], a[212:215], v[136:139], v[220:223]
    v_exp_f32 v151, v151
    v_mfma_f32_16x16x32_bf16 v[220:223], a[208:211], v[132:135], v[220:223]
    v_exp_f32 v152, v152
    v_mfma_f32_16x16x32_bf16 v[224:227], a[224:227], v[132:135], 0
    v_exp_f32 v153, v153
    v_mfma_f32_16x16x32_bf16 v[224:227], a[228:231], v[136:139], v[224:227]
    v_exp_f32 v154, v154
    v_mfma_f32_16x16x32_bf16 v[224:227], a[232:235], v[140:143], v[224:227]
    v_exp_f32 v155, v155
    v_mfma_f32_16x16x32_bf16 v[224:227], a[236:239], v[144:147], v[224:227]
    v_exp_f32 v156, v156
    v_mfma_f32_16x16x32_bf16 v[228:231], a[252:255], v[144:147], 0
    v_exp_f32 v157, v157
    v_mfma_f32_16x16x32_bf16 v[228:231], a[248:251], v[140:143], v[228:231]
    v_exp_f32 v158, v158
    v_mfma_f32_16x16x32_bf16 v[228:231], a[244:247], v[136:139], v[228:231]
    buffer_load_dwordx4 v248, s[8:11], s37 offen nt lds
    v_mfma_f32_16x16x32_bf16 v[228:231], a[240:243], v[132:135], v[228:231]
    s_mov_b32 s37, s35
    v_exp_f32 v159, v159
    v_mfma_f32_16x16x32_bf16 v[240:243], a[128:131], v[116:119], 0
    s_add_u32 s35, s35, 13107200
    v_exp_f32 v160, v160
    v_mfma_f32_16x16x32_bf16 v[240:243], a[132:135], v[120:123], v[240:243]
    v_exp_f32 v161, v161
    v_mfma_f32_16x16x32_bf16 v[240:243], a[136:139], v[124:127], v[240:243]
    v_exp_f32 v162, v162
    v_mfma_f32_16x16x32_bf16 v[240:243], a[140:143], v[128:131], v[240:243]
    s_nop 0
    v_exp_f32 v163, v163
    v_mfma_f32_16x16x32_bf16 v[232:235], a[156:159], v[128:131], 0
    s_nop 0
    v_cvt_pk_bf16_f32 v177, v150, v151
    v_cvt_pk_bf16_f32 v178, v152, v153
    v_mfma_f32_16x16x32_bf16 v[232:235], a[152:155], v[124:127], v[232:235]
    s_nop 0
    v_cvt_pk_bf16_f32 v192, v240, v241
    v_cvt_pk_bf16_f32 v193, v242, v243
    v_mfma_f32_16x16x32_bf16 v[232:235], a[148:151], v[120:123], v[232:235]
    v_cvt_pk_bf16_f32 v179, v154, v155
    v_cvt_pk_bf16_f32 v180, v156, v157
    v_mfma_f32_16x16x32_bf16 v[232:235], a[144:147], v[116:119], v[232:235]
    v_cvt_pk_bf16_f32 v181, v158, v159
    v_cvt_pk_bf16_f32 v182, v160, v161
    v_mfma_f32_16x16x32_bf16 v[236:239], a[160:163], v[116:119], 0
    ds_read_b128 v[132:135], v245 offset:8704
    v_cvt_pk_bf16_f32 v183, v162, v163
    v_mfma_f32_16x16x32_bf16 v[236:239], a[164:167], v[120:123], v[236:239]
    v_exp_f32 v164, v164
    v_mfma_f32_16x16x32_bf16 v[236:239], a[168:171], v[124:127], v[236:239]
    v_exp_f32 v165, v165
    v_mfma_f32_16x16x32_bf16 v[236:239], a[172:175], v[128:131], v[236:239]
    v_exp_f32 v166, v166
    v_mfma_f32_16x16x32_bf16 v[240:243], a[188:191], v[128:131], 0
    v_exp_f32 v167, v167
    v_mfma_f32_16x16x32_bf16 v[240:243], a[184:187], v[124:127], v[240:243]
    v_exp_f32 v168, v168
    v_mfma_f32_16x16x32_bf16 v[240:243], a[180:183], v[120:123], v[240:243]
    v_exp_f32 v169, v169
    v_mfma_f32_16x16x32_bf16 v[240:243], a[176:179], v[116:119], v[240:243]
    buffer_store_dwordx4 v[104:107], v246, s[12:15], s34 offen offset:2048 sc0 sc1
    v_cvt_pk_bf16_f32 v184, v164, v165
    v_mfma_f32_16x16x4_4b_bf16 v[200:215], v[108:109], v[188:189], 0
    v_exp_f32 v170, v170
    v_exp_f32 v171, v171
    v_cvt_pk_bf16_f32 v185, v166, v167
    v_cvt_pk_bf16_f32 v186, v168, v169
    v_cvt_pk_bf16_f32 v187, v170, v171
    v_cvt_pk_bf16_f32 v194, v232, v233
    v_smfmac_f32_16x16x64_bf16 v[172:175], v[112:115], v[176:183], v244
    s_add_u32 s34, s33, 20480
    v_cvt_pk_bf16_f32 v195, v234, v235
    v_smfmac_f32_16x16x64_bf16 v[172:175], v[110:113], v[184:191], v244
    s_nop 0
    v_cvt_pk_bf16_f32 v196, v236, v237
    v_mfma_f32_16x16x32_bf16 v[200:203], v[56:59], v[176:179], v[200:203]
    s_nop 0
    v_cvt_pk_bf16_f32 v197, v238, v239
    v_cvt_pk_bf16_f32 v198, v240, v241
    v_mfma_f32_16x16x32_bf16 v[200:203], v[72:75], v[180:183], v[200:203]
    s_nop 0
    v_add_f32 v174, v174, v175
    v_cvt_pk_bf16_f32 v199, v242, v243
    v_mfma_f32_16x16x32_bf16 v[200:203], v[88:91], v[184:187], v[200:203]
    s_nop 0
    v_rcp_f32 v253, v174
    v_mfma_f32_16x16x32_bf16 v[204:207], v[92:95], v[184:187], v[204:207]
    s_nop 0
    ds_read_b128 v[136:139], v245 offset:8768
    v_maximum3_f32 v252, v252, v174, v253
    v_mfma_f32_16x16x32_bf16 v[204:207], v[76:79], v[180:183], v[204:207]
    s_nop 0
    v_fma_f32 v200, v200, v253, v216
    v_fma_f32 v201, v201, v253, v217
    v_mfma_f32_16x16x32_bf16 v[204:207], v[60:63], v[176:179], v[204:207]
    v_fma_f32 v202, v202, v253, v218
    v_fma_f32 v203, v203, v253, v219
    v_mfma_f32_16x16x32_bf16 v[208:211], v[64:67], v[176:179], v[208:211]
    s_nop 0
    ds_read_b128 v[140:143], v245 offset:8832
    ds_read_b128 v[144:147], v245 offset:8896
    v_mfma_f32_16x16x32_bf16 v[208:211], v[80:83], v[180:183], v[208:211]
    s_nop 0
    v_fma_f32 v204, v204, v253, v220
    v_fma_f32 v205, v205, v253, v221
    v_mfma_f32_16x16x32_bf16 v[208:211], v[96:99], v[184:187], v[208:211]
    v_fma_f32 v206, v206, v253, v222
    v_fma_f32 v207, v207, v253, v223
    v_mfma_f32_16x16x32_bf16 v[212:215], v[100:103], v[184:187], v[212:215]
    s_nop 0
    v_cvt_pk_bf16_f32 v200, v200, v201
    v_cvt_pk_bf16_f32 v201, v202, v203
    v_mfma_f32_16x16x32_bf16 v[212:215], v[84:87], v[180:183], v[212:215]
    s_nop 0
    v_fma_f32 v208, v208, v253, v224
    v_fma_f32 v209, v209, v253, v225
    v_mfma_f32_16x16x32_bf16 v[212:215], v[68:71], v[176:179], v[212:215]
    v_fma_f32 v210, v210, v253, v226
    v_fma_f32 v211, v211, v253, v227
    v_mfma_f32_16x16x32_bf16 v[172:175], v[48:51], v[192:195], 0
    s_nop 0
    v_cvt_pk_bf16_f32 v202, v204, v205
    v_cvt_pk_bf16_f32 v203, v206, v207
    v_mfma_f32_16x16x32_bf16 v[172:175], v[52:55], v[196:199], v[172:175]
    s_nop 0
    v_fma_f32 v212, v212, v253, v228
    v_fma_f32 v213, v213, v253, v229
    v_mfma_f32_16x16x32_bf16 v[148:151], v[4:7], v[196:199], 4.0
    v_fma_f32 v214, v214, v253, v230
    v_fma_f32 v215, v215, v253, v231
    v_mfma_f32_16x16x32_bf16 v[148:151], v[0:3], v[192:195], v[148:151]
    s_nop 0
    v_exp_f32 v172, v172
    v_mfma_f32_16x16x32_bf16 v[152:155], v[8:11], v[192:195], 4.0
    s_waitcnt lgkmcnt(0)
    v_exp_f32 v173, v173
    v_mfma_f32_16x16x32_bf16 v[152:155], v[12:15], v[196:199], v[152:155]
    v_cvt_pk_bf16_f32 v104, v208, v209
    v_cvt_pk_bf16_f32 v105, v210, v211
    v_mfma_f32_16x16x32_bf16 v[156:159], v[20:23], v[196:199], 4.0
    v_cvt_pk_bf16_f32 v106, v212, v213
    v_cvt_pk_bf16_f32 v107, v214, v215
    v_mfma_f32_16x16x32_bf16 v[156:159], v[16:19], v[192:195], v[156:159]
    v_cvt_pk_bf16_f32 v188, v172, v173
    v_cvt_pk_bf16_f32 v189, v172, v173
    v_mfma_f32_16x16x32_bf16 v[160:163], v[24:27], v[192:195], 4.0
    v_cndmask_b32_dpp v204, v104, v200, vcc row_ror:8 row_mask:0xf bank_mask:0xf
    v_cndmask_b32_dpp v205, v105, v201, vcc row_ror:8 row_mask:0xf bank_mask:0xf
    v_mfma_f32_16x16x32_bf16 v[160:163], v[28:31], v[196:199], v[160:163]
    v_cndmask_b32_dpp v206, v106, v202, vcc row_ror:8 row_mask:0xf bank_mask:0xf
    v_cndmask_b32_dpp v207, v107, v203, vcc row_ror:8 row_mask:0xf bank_mask:0xf
    v_mfma_f32_16x16x32_bf16 v[164:167], v[36:39], v[196:199], 4.0
    v_pk_max_i16 v204, v204, 0
    v_pk_max_i16 v205, v205, 0
    v_mfma_f32_16x16x32_bf16 v[164:167], v[32:35], v[192:195], v[164:167]
    v_pk_max_i16 v206, v206, 0
    v_pk_max_i16 v207, v207, 0
    v_mfma_f32_16x16x32_bf16 v[168:171], v[40:43], v[192:195], 4.0
    v_mov_b32_dpp v104, v200 row_ror:8 row_mask:0xf bank_mask:0x3
    v_mov_b32_dpp v105, v201 row_ror:8 row_mask:0xf bank_mask:0x3
    v_mfma_f32_16x16x32_bf16 v[168:171], v[44:47], v[196:199], v[168:171]
    v_mov_b32_dpp v106, v202 row_ror:8 row_mask:0xf bank_mask:0x3
    v_mov_b32_dpp v107, v203 row_ror:8 row_mask:0xf bank_mask:0x3
    v_mfma_f32_16x16x32_bf16 v[216:219], a[192:195], v[116:119], 0
    buffer_store_dwordx4 v[204:207], v246, s[12:15], s34 offen offset:0 sc0 sc1
    v_permlane16_swap_b32 v188, v189
    v_pk_max_i16 v104, v104, 0
    v_mfma_f32_16x16x32_bf16 v[216:219], a[196:199], v[120:123], v[216:219]
    v_pk_max_i16 v105, v105, 0
    v_pk_max_i16 v106, v106, 0
    v_mfma_f32_16x16x32_bf16 v[216:219], a[200:203], v[124:127], v[216:219]
    v_exp_f32 v148, v148
    v_mfma_f32_16x16x32_bf16 v[216:219], a[204:207], v[128:131], v[216:219]
    v_exp_f32 v149, v149
    v_mfma_f32_16x16x32_bf16 v[220:223], a[220:223], v[128:131], 0
    v_pk_max_i16 v107, v107, 0
    v_cvt_pk_bf16_f32 v176, v148, v149
    v_mfma_f32_16x16x32_bf16 v[220:223], a[216:219], v[124:127], v[220:223]
    v_exp_f32 v150, v150
    v_mfma_f32_16x16x32_bf16 v[220:223], a[212:215], v[120:123], v[220:223]
    v_exp_f32 v151, v151
    v_mfma_f32_16x16x32_bf16 v[220:223], a[208:211], v[116:119], v[220:223]
    v_exp_f32 v152, v152
    v_mfma_f32_16x16x32_bf16 v[224:227], a[224:227], v[116:119], 0
    v_exp_f32 v153, v153
    v_mfma_f32_16x16x32_bf16 v[224:227], a[228:231], v[120:123], v[224:227]
    v_exp_f32 v154, v154
    v_mfma_f32_16x16x32_bf16 v[224:227], a[232:235], v[124:127], v[224:227]
    v_exp_f32 v155, v155
    v_mfma_f32_16x16x32_bf16 v[224:227], a[236:239], v[128:131], v[224:227]
    v_exp_f32 v156, v156
    v_mfma_f32_16x16x32_bf16 v[228:231], a[252:255], v[128:131], 0
    v_exp_f32 v157, v157
    v_mfma_f32_16x16x32_bf16 v[228:231], a[248:251], v[124:127], v[228:231]
    v_exp_f32 v158, v158
    v_mfma_f32_16x16x32_bf16 v[228:231], a[244:247], v[120:123], v[228:231]
    v_exp_f32 v159, v159
    v_mfma_f32_16x16x32_bf16 v[228:231], a[240:243], v[116:119], v[228:231]
    v_exp_f32 v160, v160
    v_mfma_f32_16x16x32_bf16 v[232:235], a[128:131], v[132:135], 0
    v_exp_f32 v161, v161
    v_mfma_f32_16x16x32_bf16 v[232:235], a[132:135], v[136:139], v[232:235]
    v_exp_f32 v162, v162
    v_mfma_f32_16x16x32_bf16 v[232:235], a[136:139], v[140:143], v[232:235]
    v_exp_f32 v163, v163
    v_mfma_f32_16x16x32_bf16 v[232:235], a[140:143], v[144:147], v[232:235]
    v_cvt_pk_bf16_f32 v177, v150, v151
    v_cvt_pk_bf16_f32 v178, v152, v153
    v_mfma_f32_16x16x32_bf16 v[236:239], a[156:159], v[144:147], 0
    s_nop 0
    v_cvt_pk_bf16_f32 v179, v154, v155
    v_cvt_pk_bf16_f32 v180, v156, v157
    v_mfma_f32_16x16x32_bf16 v[236:239], a[152:155], v[140:143], v[236:239]
    s_nop 0
    v_cvt_pk_bf16_f32 v192, v232, v233
    v_cvt_pk_bf16_f32 v193, v234, v235
    v_mfma_f32_16x16x32_bf16 v[236:239], a[148:151], v[136:139], v[236:239]
    v_cvt_pk_bf16_f32 v181, v158, v159
    v_cvt_pk_bf16_f32 v182, v160, v161
    v_mfma_f32_16x16x32_bf16 v[236:239], a[144:147], v[132:135], v[236:239]
    ds_read_b128 v[116:119], v245 offset:4352
    v_cvt_pk_bf16_f32 v183, v162, v163
    v_mfma_f32_16x16x32_bf16 v[240:243], a[160:163], v[132:135], 0
    v_exp_f32 v164, v164
    v_mfma_f32_16x16x32_bf16 v[240:243], a[164:167], v[136:139], v[240:243]
    v_exp_f32 v165, v165
    v_mfma_f32_16x16x32_bf16 v[240:243], a[168:171], v[140:143], v[240:243]
    v_exp_f32 v166, v166
    v_mfma_f32_16x16x32_bf16 v[240:243], a[172:175], v[144:147], v[240:243]
    v_exp_f32 v167, v167
    v_mfma_f32_16x16x32_bf16 v[232:235], a[188:191], v[144:147], 0
    v_exp_f32 v168, v168
    v_mfma_f32_16x16x32_bf16 v[232:235], a[184:187], v[140:143], v[232:235]
    v_exp_f32 v169, v169
    v_mfma_f32_16x16x32_bf16 v[232:235], a[180:183], v[136:139], v[232:235]
    v_exp_f32 v170, v170
    v_mfma_f32_16x16x32_bf16 v[232:235], a[176:179], v[132:135], v[232:235]
    buffer_store_dwordx4 v[104:107], v246, s[12:15], s34 offen offset:2048 sc0 sc1
    v_cvt_pk_bf16_f32 v184, v164, v165
    v_mfma_f32_16x16x4_4b_bf16 v[200:215], v[108:109], v[188:189], 0
    v_exp_f32 v171, v171
    v_cvt_pk_bf16_f32 v185, v166, v167
    v_cvt_pk_bf16_f32 v186, v168, v169
    v_cvt_pk_bf16_f32 v187, v170, v171
    v_cvt_pk_bf16_f32 v194, v236, v237
    v_cvt_pk_bf16_f32 v195, v238, v239
    v_cvt_pk_bf16_f32 v196, v240, v241
    v_smfmac_f32_16x16x64_bf16 v[172:175], v[112:115], v[176:183], v244
    s_add_u32 s34, s33, 12288
    v_cvt_pk_bf16_f32 v197, v242, v243
    v_smfmac_f32_16x16x64_bf16 v[172:175], v[110:113], v[184:191], v244
    v_cvt_pk_bf16_f32 v198, v232, v233
    v_mfma_f32_16x16x32_bf16 v[200:203], v[56:59], v[176:179], v[200:203]
    s_nop 0
    ds_read_b128 v[120:123], v245 offset:4416
    v_cvt_pk_bf16_f32 v199, v234, v235
    v_mfma_f32_16x16x32_bf16 v[200:203], v[72:75], v[180:183], v[200:203]
    s_nop 0
    ds_read_b128 v[124:127], v245 offset:4480
    v_add_f32 v174, v174, v175
    v_mfma_f32_16x16x32_bf16 v[200:203], v[88:91], v[184:187], v[200:203]
    s_nop 0
    v_rcp_f32 v253, v174
    v_mfma_f32_16x16x32_bf16 v[204:207], v[92:95], v[184:187], v[204:207]
    s_nop 0
    ds_read_b128 v[128:131], v245 offset:4544
    v_maximum3_f32 v252, v252, v174, v253
    v_mfma_f32_16x16x32_bf16 v[204:207], v[76:79], v[180:183], v[204:207]
    s_nop 0
    v_fma_f32 v200, v200, v253, v216
    v_fma_f32 v201, v201, v253, v217
    v_mfma_f32_16x16x32_bf16 v[204:207], v[60:63], v[176:179], v[204:207]
    v_fma_f32 v202, v202, v253, v218
    v_fma_f32 v203, v203, v253, v219
    v_mfma_f32_16x16x32_bf16 v[208:211], v[64:67], v[176:179], v[208:211]
    s_nop 0
    v_cvt_pk_bf16_f32 v200, v200, v201
    v_cvt_pk_bf16_f32 v201, v202, v203
    v_mfma_f32_16x16x32_bf16 v[208:211], v[80:83], v[180:183], v[208:211]
    s_nop 0
    v_fma_f32 v204, v204, v253, v220
    v_fma_f32 v205, v205, v253, v221
    v_mfma_f32_16x16x32_bf16 v[208:211], v[96:99], v[184:187], v[208:211]
    v_fma_f32 v206, v206, v253, v222
    v_fma_f32 v207, v207, v253, v223
    v_mfma_f32_16x16x32_bf16 v[212:215], v[100:103], v[184:187], v[212:215]
    s_nop 0
    v_cvt_pk_bf16_f32 v202, v204, v205
    v_cvt_pk_bf16_f32 v203, v206, v207
    v_mfma_f32_16x16x32_bf16 v[212:215], v[84:87], v[180:183], v[212:215]
    s_nop 0
    v_fma_f32 v208, v208, v253, v224
    v_fma_f32 v209, v209, v253, v225
    v_mfma_f32_16x16x32_bf16 v[212:215], v[68:71], v[176:179], v[212:215]
    v_fma_f32 v210, v210, v253, v226
    v_fma_f32 v211, v211, v253, v227
    v_mfma_f32_16x16x32_bf16 v[172:175], v[48:51], v[192:195], 0
    s_waitcnt lgkmcnt(0)
    v_cvt_pk_bf16_f32 v104, v208, v209
    v_cvt_pk_bf16_f32 v105, v210, v211
    v_mfma_f32_16x16x32_bf16 v[172:175], v[52:55], v[196:199], v[172:175]
    s_nop 0
    v_fma_f32 v212, v212, v253, v228
    v_fma_f32 v213, v213, v253, v229
    v_mfma_f32_16x16x32_bf16 v[148:151], v[4:7], v[196:199], 4.0
    v_fma_f32 v214, v214, v253, v230
    v_fma_f32 v215, v215, v253, v231
    v_mfma_f32_16x16x32_bf16 v[148:151], v[0:3], v[192:195], v[148:151]
    s_nop 0
    v_exp_f32 v172, v172
    v_mfma_f32_16x16x32_bf16 v[152:155], v[8:11], v[192:195], 4.0
    v_exp_f32 v173, v173
    v_mfma_f32_16x16x32_bf16 v[152:155], v[12:15], v[196:199], v[152:155]
    v_cvt_pk_bf16_f32 v106, v212, v213
    v_cvt_pk_bf16_f32 v107, v214, v215
    v_mfma_f32_16x16x32_bf16 v[156:159], v[20:23], v[196:199], 4.0
    v_cvt_pk_bf16_f32 v188, v172, v173
    v_cvt_pk_bf16_f32 v189, v172, v173
    v_mfma_f32_16x16x32_bf16 v[156:159], v[16:19], v[192:195], v[156:159]
    v_cndmask_b32_dpp v204, v104, v200, vcc row_ror:8 row_mask:0xf bank_mask:0xf
    v_cndmask_b32_dpp v205, v105, v201, vcc row_ror:8 row_mask:0xf bank_mask:0xf
    v_mfma_f32_16x16x32_bf16 v[160:163], v[24:27], v[192:195], 4.0
    v_cndmask_b32_dpp v206, v106, v202, vcc row_ror:8 row_mask:0xf bank_mask:0xf
    v_cndmask_b32_dpp v207, v107, v203, vcc row_ror:8 row_mask:0xf bank_mask:0xf
    v_mfma_f32_16x16x32_bf16 v[160:163], v[28:31], v[196:199], v[160:163]
    v_pk_max_i16 v204, v204, 0
    v_pk_max_i16 v205, v205, 0
    v_mfma_f32_16x16x32_bf16 v[164:167], v[36:39], v[196:199], 4.0
    v_pk_max_i16 v206, v206, 0
    v_pk_max_i16 v207, v207, 0
    v_mfma_f32_16x16x32_bf16 v[164:167], v[32:35], v[192:195], v[164:167]
    v_mov_b32_dpp v104, v200 row_ror:8 row_mask:0xf bank_mask:0x3
    v_mov_b32_dpp v105, v201 row_ror:8 row_mask:0xf bank_mask:0x3
    v_mfma_f32_16x16x32_bf16 v[168:171], v[40:43], v[192:195], 4.0
    v_mov_b32_dpp v106, v202 row_ror:8 row_mask:0xf bank_mask:0x3
    v_mov_b32_dpp v107, v203 row_ror:8 row_mask:0xf bank_mask:0x3
    v_mfma_f32_16x16x32_bf16 v[168:171], v[44:47], v[196:199], v[168:171]
    buffer_store_dwordx4 v[204:207], v246, s[12:15], s34 offen offset:0 sc0 sc1
    v_permlane16_swap_b32 v188, v189
    v_pk_max_i16 v104, v104, 0
    v_mfma_f32_16x16x32_bf16 v[216:219], a[192:195], v[132:135], 0
    v_pk_max_i16 v105, v105, 0
    v_pk_max_i16 v106, v106, 0
    v_mfma_f32_16x16x32_bf16 v[216:219], a[196:199], v[136:139], v[216:219]
    v_exp_f32 v148, v148
    v_mfma_f32_16x16x32_bf16 v[216:219], a[200:203], v[140:143], v[216:219]
    v_exp_f32 v149, v149
    v_mfma_f32_16x16x32_bf16 v[216:219], a[204:207], v[144:147], v[216:219]
    v_pk_max_i16 v107, v107, 0
    v_cvt_pk_bf16_f32 v176, v148, v149
    v_mfma_f32_16x16x32_bf16 v[220:223], a[220:223], v[144:147], 0
    v_exp_f32 v150, v150
    v_mfma_f32_16x16x32_bf16 v[220:223], a[216:219], v[140:143], v[220:223]
    v_exp_f32 v151, v151
    v_mfma_f32_16x16x32_bf16 v[220:223], a[212:215], v[136:139], v[220:223]
    v_exp_f32 v152, v152
    v_mfma_f32_16x16x32_bf16 v[220:223], a[208:211], v[132:135], v[220:223]
    v_exp_f32 v153, v153
    v_mfma_f32_16x16x32_bf16 v[224:227], a[224:227], v[132:135], 0
    v_exp_f32 v154, v154
    v_mfma_f32_16x16x32_bf16 v[224:227], a[228:231], v[136:139], v[224:227]
    v_exp_f32 v155, v155
    v_mfma_f32_16x16x32_bf16 v[224:227], a[232:235], v[140:143], v[224:227]
    v_exp_f32 v156, v156
    v_mfma_f32_16x16x32_bf16 v[224:227], a[236:239], v[144:147], v[224:227]
    v_exp_f32 v157, v157
    v_mfma_f32_16x16x32_bf16 v[228:231], a[252:255], v[144:147], 0
    v_exp_f32 v158, v158
    v_mfma_f32_16x16x32_bf16 v[228:231], a[248:251], v[140:143], v[228:231]
    v_exp_f32 v159, v159
    v_mfma_f32_16x16x32_bf16 v[228:231], a[244:247], v[136:139], v[228:231]
    v_exp_f32 v160, v160
    v_mfma_f32_16x16x32_bf16 v[228:231], a[240:243], v[132:135], v[228:231]
    v_exp_f32 v161, v161
    v_mfma_f32_16x16x32_bf16 v[236:239], a[128:131], v[116:119], 0
    v_exp_f32 v162, v162
    v_mfma_f32_16x16x32_bf16 v[236:239], a[132:135], v[120:123], v[236:239]
    v_exp_f32 v163, v163
    v_mfma_f32_16x16x32_bf16 v[236:239], a[136:139], v[124:127], v[236:239]
    v_cvt_pk_bf16_f32 v177, v150, v151
    v_cvt_pk_bf16_f32 v178, v152, v153
    v_mfma_f32_16x16x32_bf16 v[236:239], a[140:143], v[128:131], v[236:239]
    v_cvt_pk_bf16_f32 v179, v154, v155
    v_cvt_pk_bf16_f32 v180, v156, v157
    v_mfma_f32_16x16x32_bf16 v[240:243], a[156:159], v[128:131], 0
    s_nop 0
    v_cvt_pk_bf16_f32 v181, v158, v159
    v_cvt_pk_bf16_f32 v182, v160, v161
    v_mfma_f32_16x16x32_bf16 v[240:243], a[152:155], v[124:127], v[240:243]
    s_nop 0
    v_cvt_pk_bf16_f32 v192, v236, v237
    v_cvt_pk_bf16_f32 v193, v238, v239
    v_mfma_f32_16x16x32_bf16 v[240:243], a[148:151], v[120:123], v[240:243]
    ds_read_b128 v[132:135], v245 offset:0
    v_cvt_pk_bf16_f32 v183, v162, v163
    v_mfma_f32_16x16x32_bf16 v[240:243], a[144:147], v[116:119], v[240:243]
    v_exp_f32 v164, v164
    v_mfma_f32_16x16x32_bf16 v[232:235], a[160:163], v[116:119], 0
    v_exp_f32 v165, v165
    v_mfma_f32_16x16x32_bf16 v[232:235], a[164:167], v[120:123], v[232:235]
    v_exp_f32 v166, v166
    v_mfma_f32_16x16x32_bf16 v[232:235], a[168:171], v[124:127], v[232:235]
    v_exp_f32 v167, v167
    v_mfma_f32_16x16x32_bf16 v[232:235], a[172:175], v[128:131], v[232:235]
    v_exp_f32 v168, v168
    v_mfma_f32_16x16x32_bf16 v[236:239], a[188:191], v[128:131], 0
    v_exp_f32 v169, v169
    v_mfma_f32_16x16x32_bf16 v[236:239], a[184:187], v[124:127], v[236:239]
    v_exp_f32 v170, v170
    v_mfma_f32_16x16x32_bf16 v[236:239], a[180:183], v[120:123], v[236:239]
    v_exp_f32 v171, v171
    v_mfma_f32_16x16x32_bf16 v[236:239], a[176:179], v[116:119], v[236:239]
    buffer_store_dwordx4 v[104:107], v246, s[12:15], s34 offen offset:2048 sc0 sc1
    v_cvt_pk_bf16_f32 v184, v164, v165
    v_mfma_f32_16x16x4_4b_bf16 v[200:215], v[108:109], v[188:189], 0
    v_cvt_pk_bf16_f32 v185, v166, v167
    v_cvt_pk_bf16_f32 v186, v168, v169
    v_cvt_pk_bf16_f32 v187, v170, v171
    v_cvt_pk_bf16_f32 v194, v240, v241
    v_cvt_pk_bf16_f32 v195, v242, v243
    v_cvt_pk_bf16_f32 v196, v232, v233
    v_cvt_pk_bf16_f32 v197, v234, v235
    v_cvt_pk_bf16_f32 v198, v236, v237
    v_smfmac_f32_16x16x64_bf16 v[172:175], v[112:115], v[176:183], v244
    s_add_u32 s34, s33, 8192
    v_cvt_pk_bf16_f32 v199, v238, v239
    v_smfmac_f32_16x16x64_bf16 v[172:175], v[110:113], v[184:191], v244
    s_nop 0
    ds_read_b128 v[136:139], v245 offset:64
    v_mfma_f32_16x16x32_bf16 v[200:203], v[56:59], v[176:179], v[200:203]
    s_nop 0
    ds_read_b128 v[140:143], v245 offset:128
    ds_read_b128 v[144:147], v245 offset:192
    v_mfma_f32_16x16x32_bf16 v[200:203], v[72:75], v[180:183], v[200:203]
    s_nop 0
    v_add_f32 v174, v174, v175
    v_add_u32 v245, s39, v245
    v_mfma_f32_16x16x32_bf16 v[200:203], v[88:91], v[184:187], v[200:203]
    s_sub_u32 s39, 0, s39
    v_rcp_f32 v253, v174
    v_mfma_f32_16x16x32_bf16 v[204:207], v[92:95], v[184:187], v[204:207]
    s_nop 0
    v_maximum3_f32 v252, v252, v174, v253
    s_nop 0
    v_mfma_f32_16x16x32_bf16 v[204:207], v[76:79], v[180:183], v[204:207]
    s_nop 0
    v_fma_f32 v200, v200, v253, v216
    v_fma_f32 v201, v201, v253, v217
    v_mfma_f32_16x16x32_bf16 v[204:207], v[60:63], v[176:179], v[204:207]
    v_fma_f32 v202, v202, v253, v218
    v_fma_f32 v203, v203, v253, v219
    v_mfma_f32_16x16x32_bf16 v[208:211], v[64:67], v[176:179], v[208:211]
    s_nop 0
    v_cvt_pk_bf16_f32 v200, v200, v201
    v_cvt_pk_bf16_f32 v201, v202, v203
    v_mfma_f32_16x16x32_bf16 v[208:211], v[80:83], v[180:183], v[208:211]
    s_nop 0
    v_fma_f32 v204, v204, v253, v220
    v_fma_f32 v205, v205, v253, v221
    v_mfma_f32_16x16x32_bf16 v[208:211], v[96:99], v[184:187], v[208:211]
    v_fma_f32 v206, v206, v253, v222
    v_fma_f32 v207, v207, v253, v223
    v_mfma_f32_16x16x32_bf16 v[212:215], v[100:103], v[184:187], v[212:215]
    s_nop 0
    v_cvt_pk_bf16_f32 v202, v204, v205
    v_cvt_pk_bf16_f32 v203, v206, v207
    v_mfma_f32_16x16x32_bf16 v[212:215], v[84:87], v[180:183], v[212:215]
    s_waitcnt lgkmcnt(0)
    v_fma_f32 v208, v208, v253, v224
    v_fma_f32 v209, v209, v253, v225
    v_mfma_f32_16x16x32_bf16 v[212:215], v[68:71], v[176:179], v[212:215]
    s_mov_b32 m0, s6
    v_fma_f32 v210, v210, v253, v226
    v_fma_f32 v211, v211, v253, v227
    v_mfma_f32_16x16x32_bf16 v[172:175], v[48:51], v[192:195], 0
    v_cvt_pk_bf16_f32 v104, v208, v209
    v_cvt_pk_bf16_f32 v105, v210, v211
    v_mfma_f32_16x16x32_bf16 v[172:175], v[52:55], v[196:199], v[172:175]
    s_nop 0
    v_fma_f32 v212, v212, v253, v228
    v_fma_f32 v213, v213, v253, v229
    v_mfma_f32_16x16x32_bf16 v[148:151], v[4:7], v[196:199], 4.0
    v_fma_f32 v214, v214, v253, v230
    v_fma_f32 v215, v215, v253, v231
    v_mfma_f32_16x16x32_bf16 v[148:151], v[0:3], v[192:195], v[148:151]
    s_nop 0
    v_exp_f32 v172, v172
    v_mfma_f32_16x16x32_bf16 v[152:155], v[8:11], v[192:195], 4.0
    v_exp_f32 v173, v173
    v_mfma_f32_16x16x32_bf16 v[152:155], v[12:15], v[196:199], v[152:155]
    v_cvt_pk_bf16_f32 v106, v212, v213
    v_cvt_pk_bf16_f32 v107, v214, v215
    v_mfma_f32_16x16x32_bf16 v[156:159], v[20:23], v[196:199], 4.0
    v_cvt_pk_bf16_f32 v188, v172, v173
    v_cvt_pk_bf16_f32 v189, v172, v173
    v_mfma_f32_16x16x32_bf16 v[156:159], v[16:19], v[192:195], v[156:159]
    v_cndmask_b32_dpp v204, v104, v200, vcc row_ror:8 row_mask:0xf bank_mask:0xf
    v_cndmask_b32_dpp v205, v105, v201, vcc row_ror:8 row_mask:0xf bank_mask:0xf
    v_mfma_f32_16x16x32_bf16 v[160:163], v[24:27], v[192:195], 4.0
    v_cndmask_b32_dpp v206, v106, v202, vcc row_ror:8 row_mask:0xf bank_mask:0xf
    v_cndmask_b32_dpp v207, v107, v203, vcc row_ror:8 row_mask:0xf bank_mask:0xf
    v_mfma_f32_16x16x32_bf16 v[160:163], v[28:31], v[196:199], v[160:163]
    v_pk_max_i16 v204, v204, 0
    v_pk_max_i16 v205, v205, 0
    v_mfma_f32_16x16x32_bf16 v[164:167], v[36:39], v[196:199], 4.0
    v_pk_max_i16 v206, v206, 0
    v_pk_max_i16 v207, v207, 0
    v_mfma_f32_16x16x32_bf16 v[164:167], v[32:35], v[192:195], v[164:167]
    v_mov_b32_dpp v104, v200 row_ror:8 row_mask:0xf bank_mask:0x3
    v_mov_b32_dpp v105, v201 row_ror:8 row_mask:0xf bank_mask:0x3
    v_mfma_f32_16x16x32_bf16 v[168:171], v[40:43], v[192:195], 4.0
    v_mov_b32_dpp v106, v202 row_ror:8 row_mask:0xf bank_mask:0x3
    v_mov_b32_dpp v107, v203 row_ror:8 row_mask:0xf bank_mask:0x3
    v_mfma_f32_16x16x32_bf16 v[168:171], v[44:47], v[196:199], v[168:171]
    buffer_store_dwordx4 v[204:207], v246, s[12:15], s34 offen offset:0 sc0 sc1
    v_permlane16_swap_b32 v188, v189
    v_pk_max_i16 v104, v104, 0
    v_mfma_f32_16x16x32_bf16 v[216:219], a[192:195], v[116:119], 0
    s_waitcnt vmcnt(6)
    ds_write_addtid_b32 v245
    v_pk_max_i16 v105, v105, 0
    v_mfma_f32_16x16x32_bf16 v[216:219], a[196:199], v[120:123], v[216:219]
    s_mov_b32 m0, s7
    v_pk_max_i16 v106, v106, 0
    v_pk_max_i16 v107, v107, 0
    v_mfma_f32_16x16x32_bf16 v[216:219], a[200:203], v[124:127], v[216:219]
    s_lshr_b32 s56, 0x118, s32
    v_exp_f32 v148, v148
    v_mfma_f32_16x16x32_bf16 v[216:219], a[204:207], v[128:131], v[216:219]
    s_and_b32 s56, s56, 1
    v_exp_f32 v149, v149
    v_mfma_f32_16x16x32_bf16 v[220:223], a[220:223], v[128:131], 0
    v_exp_f32 v150, v150
    v_mfma_f32_16x16x32_bf16 v[220:223], a[216:219], v[124:127], v[220:223]
    v_exp_f32 v151, v151
    v_mfma_f32_16x16x32_bf16 v[220:223], a[212:215], v[120:123], v[220:223]
    v_exp_f32 v152, v152
    v_mfma_f32_16x16x32_bf16 v[220:223], a[208:211], v[116:119], v[220:223]
    v_exp_f32 v153, v153
    v_mfma_f32_16x16x32_bf16 v[224:227], a[224:227], v[116:119], 0
    v_exp_f32 v154, v154
    v_mfma_f32_16x16x32_bf16 v[224:227], a[228:231], v[120:123], v[224:227]
    v_exp_f32 v155, v155
    v_mfma_f32_16x16x32_bf16 v[224:227], a[232:235], v[124:127], v[224:227]
    v_exp_f32 v156, v156
    v_mfma_f32_16x16x32_bf16 v[224:227], a[236:239], v[128:131], v[224:227]
    v_exp_f32 v157, v157
    v_mfma_f32_16x16x32_bf16 v[228:231], a[252:255], v[128:131], 0
    v_exp_f32 v158, v158
    v_mfma_f32_16x16x32_bf16 v[228:231], a[248:251], v[124:127], v[228:231]
    v_exp_f32 v159, v159
    v_mfma_f32_16x16x32_bf16 v[228:231], a[244:247], v[120:123], v[228:231]
    v_exp_f32 v160, v160
    v_mfma_f32_16x16x32_bf16 v[228:231], a[240:243], v[116:119], v[228:231]
    v_exp_f32 v161, v161
    v_mfma_f32_16x16x32_bf16 v[240:243], a[128:131], v[132:135], 0
    ds_read_addtid_b32 v116
    v_cvt_pk_bf16_f32 v176, v148, v149
    v_mfma_f32_16x16x32_bf16 v[240:243], a[132:135], v[136:139], v[240:243]
    s_mov_b32 m0, s36
    v_exp_f32 v162, v162
    v_mfma_f32_16x16x32_bf16 v[240:243], a[136:139], v[140:143], v[240:243]
    s_sub_u32 s36, s38, s36
    v_exp_f32 v163, v163
    v_mfma_f32_16x16x32_bf16 v[240:243], a[140:143], v[144:147], v[240:243]
    v_cvt_pk_bf16_f32 v177, v150, v151
    v_cvt_pk_bf16_f32 v178, v152, v153
    v_mfma_f32_16x16x32_bf16 v[232:235], a[156:159], v[144:147], 0
    s_nop 0
    v_cvt_pk_bf16_f32 v179, v154, v155
    v_cvt_pk_bf16_f32 v180, v156, v157
    v_mfma_f32_16x16x32_bf16 v[232:235], a[152:155], v[140:143], v[232:235]
    s_nop 0
    v_cvt_pk_bf16_f32 v192, v240, v241
    v_cvt_pk_bf16_f32 v193, v242, v243
    v_mfma_f32_16x16x32_bf16 v[232:235], a[148:151], v[136:139], v[232:235]
    v_cvt_pk_bf16_f32 v181, v158, v159
    v_cvt_pk_bf16_f32 v182, v160, v161
    v_mfma_f32_16x16x32_bf16 v[232:235], a[144:147], v[132:135], v[232:235]
    ds_read_b128 v[120:123], v245 offset:64
    v_cvt_pk_bf16_f32 v183, v162, v163
    v_mfma_f32_16x16x32_bf16 v[236:239], a[160:163], v[132:135], 0
    v_exp_f32 v164, v164
    v_mfma_f32_16x16x32_bf16 v[236:239], a[164:167], v[136:139], v[236:239]
    s_waitcnt lgkmcnt(1)
    v_exp_f32 v165, v165
    v_mfma_f32_16x16x32_bf16 v[236:239], a[168:171], v[140:143], v[236:239]
    v_exp_f32 v166, v166
    v_mfma_f32_16x16x32_bf16 v[236:239], a[172:175], v[144:147], v[236:239]
    v_exp_f32 v167, v167
    v_mfma_f32_16x16x32_bf16 v[240:243], a[188:191], v[144:147], 0
    v_exp_f32 v168, v168
    v_mfma_f32_16x16x32_bf16 v[240:243], a[184:187], v[140:143], v[240:243]
    v_exp_f32 v169, v169
    v_mfma_f32_16x16x32_bf16 v[240:243], a[180:183], v[136:139], v[240:243]
    v_exp_f32 v170, v170
    v_mfma_f32_16x16x32_bf16 v[240:243], a[176:179], v[132:135], v[240:243]
    buffer_store_dwordx4 v[104:107], v246, s[12:15], s34 offen offset:2048 sc0 sc1
    v_cmp_ne_u32 s[54:55], v116, v245
    v_mfma_f32_16x16x4_4b_bf16 v[200:215], v[108:109], v[188:189], 0
    v_exp_f32 v171, v171
    v_cvt_pk_bf16_f32 v184, v164, v165
    v_cvt_pk_bf16_f32 v185, v166, v167
    v_cvt_pk_bf16_f32 v186, v168, v169
    v_cvt_pk_bf16_f32 v187, v170, v171
    v_cvt_pk_bf16_f32 v194, v232, v233
    v_cvt_pk_bf16_f32 v195, v234, v235
    v_smfmac_f32_16x16x64_bf16 v[172:175], v[112:115], v[176:183], v244
    s_or_b32 s56, s56, s54
    s_add_u32 s34, s33, 4096
    v_cvt_pk_bf16_f32 v196, v236, v237
    v_smfmac_f32_16x16x64_bf16 v[172:175], v[110:113], v[184:191], v244
    v_cvt_pk_bf16_f32 v197, v238, v239
    v_mfma_f32_16x16x32_bf16 v[200:203], v[56:59], v[176:179], v[200:203]
    s_nop 0
    v_cvt_pk_bf16_f32 v198, v240, v241
    v_cvt_pk_bf16_f32 v199, v242, v243
    v_mfma_f32_16x16x32_bf16 v[200:203], v[72:75], v[180:183], v[200:203]
    s_nop 0
    ds_read_b128 v[116:119], v245 offset:0
    v_add_f32 v174, v174, v175
    v_mfma_f32_16x16x32_bf16 v[200:203], v[88:91], v[184:187], v[200:203]
    s_nop 0
    v_rcp_f32 v253, v174
    v_mfma_f32_16x16x32_bf16 v[204:207], v[92:95], v[184:187], v[204:207]
    s_nop 0
    ds_read_b128 v[124:127], v245 offset:128
    v_maximum3_f32 v252, v252, v174, v253
    v_mfma_f32_16x16x32_bf16 v[204:207], v[76:79], v[180:183], v[204:207]
    s_nop 0
    v_fma_f32 v200, v200, v253, v216
    v_fma_f32 v201, v201, v253, v217
    v_mfma_f32_16x16x32_bf16 v[204:207], v[60:63], v[176:179], v[204:207]
    v_fma_f32 v202, v202, v253, v218
    v_fma_f32 v203, v203, v253, v219
    v_mfma_f32_16x16x32_bf16 v[208:211], v[64:67], v[176:179], v[208:211]
    s_nop 0
    ds_read_b128 v[128:131], v245 offset:192
    v_cvt_pk_bf16_f32 v200, v200, v201
    v_mfma_f32_16x16x32_bf16 v[208:211], v[80:83], v[180:183], v[208:211]
    s_nop 0
    v_fma_f32 v204, v204, v253, v220
    v_fma_f32 v205, v205, v253, v221
    v_mfma_f32_16x16x32_bf16 v[208:211], v[96:99], v[184:187], v[208:211]
    v_fma_f32 v206, v206, v253, v222
    v_fma_f32 v207, v207, v253, v223
    v_mfma_f32_16x16x32_bf16 v[212:215], v[100:103], v[184:187], v[212:215]
    s_nop 0
    v_cvt_pk_bf16_f32 v201, v202, v203
    v_cvt_pk_bf16_f32 v202, v204, v205
    v_mfma_f32_16x16x32_bf16 v[212:215], v[84:87], v[180:183], v[212:215]
    s_nop 0
    v_fma_f32 v208, v208, v253, v224
    v_fma_f32 v209, v209, v253, v225
    v_mfma_f32_16x16x32_bf16 v[212:215], v[68:71], v[176:179], v[212:215]
    v_fma_f32 v210, v210, v253, v226
    v_fma_f32 v211, v211, v253, v227
    v_mfma_f32_16x16x32_bf16 v[172:175], v[48:51], v[192:195], 0
    s_nop 0
    v_cvt_pk_bf16_f32 v203, v206, v207
    v_cvt_pk_bf16_f32 v104, v208, v209
    v_mfma_f32_16x16x32_bf16 v[172:175], v[52:55], v[196:199], v[172:175]
    s_nop 0
    v_fma_f32 v212, v212, v253, v228
    v_fma_f32 v213, v213, v253, v229
    v_mfma_f32_16x16x32_bf16 v[148:151], v[4:7], v[196:199], 4.0
    v_fma_f32 v214, v214, v253, v230
    v_fma_f32 v215, v215, v253, v231
    v_mfma_f32_16x16x32_bf16 v[148:151], v[0:3], v[192:195], v[148:151]
    s_waitcnt lgkmcnt(0)
    v_exp_f32 v172, v172
    v_mfma_f32_16x16x32_bf16 v[152:155], v[8:11], v[192:195], 4.0
    v_exp_f32 v173, v173
    v_mfma_f32_16x16x32_bf16 v[152:155], v[12:15], v[196:199], v[152:155]
    v_cvt_pk_bf16_f32 v105, v210, v211
    v_cvt_pk_bf16_f32 v106, v212, v213
    v_mfma_f32_16x16x32_bf16 v[156:159], v[20:23], v[196:199], 4.0
    v_cvt_pk_bf16_f32 v107, v214, v215
    v_cvt_pk_bf16_f32 v188, v172, v173
    v_mfma_f32_16x16x32_bf16 v[156:159], v[16:19], v[192:195], v[156:159]
    v_cvt_pk_bf16_f32 v189, v172, v173
    v_cndmask_b32_dpp v204, v104, v200, vcc row_ror:8 row_mask:0xf bank_mask:0xf
    v_mfma_f32_16x16x32_bf16 v[160:163], v[24:27], v[192:195], 4.0
    v_cndmask_b32_dpp v205, v105, v201, vcc row_ror:8 row_mask:0xf bank_mask:0xf
    v_cndmask_b32_dpp v206, v106, v202, vcc row_ror:8 row_mask:0xf bank_mask:0xf
    v_mfma_f32_16x16x32_bf16 v[160:163], v[28:31], v[196:199], v[160:163]
    v_cndmask_b32_dpp v207, v107, v203, vcc row_ror:8 row_mask:0xf bank_mask:0xf
    v_pk_max_i16 v204, v204, 0
    v_mfma_f32_16x16x32_bf16 v[164:167], v[36:39], v[196:199], 4.0
    v_pk_max_i16 v205, v205, 0
    v_pk_max_i16 v206, v206, 0
    v_mfma_f32_16x16x32_bf16 v[164:167], v[32:35], v[192:195], v[164:167]
    v_pk_max_i16 v207, v207, 0
    v_mov_b32_dpp v104, v200 row_ror:8 row_mask:0xf bank_mask:0x3
    v_mfma_f32_16x16x32_bf16 v[168:171], v[40:43], v[192:195], 4.0
    v_mov_b32_dpp v105, v201 row_ror:8 row_mask:0xf bank_mask:0x3
    v_mov_b32_dpp v106, v202 row_ror:8 row_mask:0xf bank_mask:0x3
    v_mfma_f32_16x16x32_bf16 v[168:171], v[44:47], v[196:199], v[168:171]
    v_mov_b32_dpp v107, v203 row_ror:8 row_mask:0xf bank_mask:0x3
    v_pk_max_i16 v104, v104, 0
    v_mfma_f32_16x16x32_bf16 v[216:219], a[192:195], v[132:135], 0
    buffer_store_dwordx4 v[204:207], v246, s[12:15], s34 offen offset:0 sc0 sc1
    v_permlane16_swap_b32 v188, v189
    v_pk_max_i16 v105, v105, 0
    v_mfma_f32_16x16x32_bf16 v[216:219], a[196:199], v[136:139], v[216:219]
    v_pk_max_i16 v106, v106, 0
    v_pk_max_i16 v107, v107, 0
    v_mfma_f32_16x16x32_bf16 v[216:219], a[200:203], v[140:143], v[216:219]
    v_exp_f32 v148, v148
    v_mfma_f32_16x16x32_bf16 v[216:219], a[204:207], v[144:147], v[216:219]
    v_exp_f32 v149, v149
    v_mfma_f32_16x16x32_bf16 v[220:223], a[220:223], v[144:147], 0
    v_exp_f32 v150, v150
    v_mfma_f32_16x16x32_bf16 v[220:223], a[216:219], v[140:143], v[220:223]
    v_exp_f32 v151, v151
    v_mfma_f32_16x16x32_bf16 v[220:223], a[212:215], v[136:139], v[220:223]
    v_exp_f32 v152, v152
    v_mfma_f32_16x16x32_bf16 v[220:223], a[208:211], v[132:135], v[220:223]
    v_exp_f32 v153, v153
    v_mfma_f32_16x16x32_bf16 v[224:227], a[224:227], v[132:135], 0
    v_exp_f32 v154, v154
    v_mfma_f32_16x16x32_bf16 v[224:227], a[228:231], v[136:139], v[224:227]
    v_exp_f32 v155, v155
    v_mfma_f32_16x16x32_bf16 v[224:227], a[232:235], v[140:143], v[224:227]
    v_exp_f32 v156, v156
    v_mfma_f32_16x16x32_bf16 v[224:227], a[236:239], v[144:147], v[224:227]
    v_exp_f32 v157, v157
    v_mfma_f32_16x16x32_bf16 v[228:231], a[252:255], v[144:147], 0
    v_exp_f32 v158, v158
    v_mfma_f32_16x16x32_bf16 v[228:231], a[248:251], v[140:143], v[228:231]
    v_exp_f32 v159, v159
    v_mfma_f32_16x16x32_bf16 v[228:231], a[244:247], v[136:139], v[228:231]
    s_or_b32 s56, s56, s55
    v_exp_f32 v160, v160
    v_mfma_f32_16x16x32_bf16 v[228:231], a[240:243], v[132:135], v[228:231]
    s_cbranch_scc0 L_body
    s_branch L_side
L_pad5:
    s_branch L_touched2
.p2align 12
L_pad2:
    s_branch L_touched
L_body:
    v_mfma_f32_16x16x32_bf16 v[232:235], a[0:3], v[116:119], 0
    s_add_u32 s32, s32, 1
    v_exp_f32 v161, v161
    v_mfma_f32_16x16x32_bf16 v[232:235], a[4:7], v[120:123], v[232:235]
    v_exp_f32 v162, v162
    v_mfma_f32_16x16x32_bf16 v[232:235], a[8:11], v[124:127], v[232:235]
    v_exp_f32 v163, v163
    v_mfma_f32_16x16x32_bf16 v[232:235], a[12:15], v[128:131], v[232:235]
    v_cvt_pk_bf16_f32 v176, v148, v149
    v_cvt_pk_bf16_f32 v177, v150, v151
    v_mfma_f32_16x16x32_bf16 v[236:239], a[28:31], v[128:131], 0
    s_nop 0
    v_cvt_pk_bf16_f32 v178, v152, v153
    v_cvt_pk_bf16_f32 v179, v154, v155
    v_mfma_f32_16x16x32_bf16 v[236:239], a[24:27], v[124:127], v[236:239]
    s_nop 0
    v_cvt_pk_bf16_f32 v0, v232, v233
    v_cvt_pk_bf16_f32 v1, v234, v235
    v_mfma_f32_16x16x32_bf16 v[236:239], a[20:23], v[120:123], v[236:239]
    buffer_load_dwordx4 v248, s[8:11], s37 offen nt lds
    v_mfma_f32_16x16x32_bf16 v[236:239], a[16:19], v[116:119], v[236:239]
    s_addk_i32 m0, 2176
    v_cvt_pk_bf16_f32 v180, v156, v157
    v_cvt_pk_bf16_f32 v181, v158, v159
    v_mfma_f32_16x16x32_bf16 v[240:243], a[32:35], v[116:119], 0
    s_addk_i32 s37, 2048
    v_cvt_pk_bf16_f32 v182, v160, v161
    v_cvt_pk_bf16_f32 v183, v162, v163
    v_mfma_f32_16x16x32_bf16 v[240:243], a[36:39], v[120:123], v[240:243]
    v_exp_f32 v164, v164
    v_mfma_f32_16x16x32_bf16 v[240:243], a[40:43], v[124:127], v[240:243]
    v_exp_f32 v165, v165
    v_mfma_f32_16x16x32_bf16 v[240:243], a[44:47], v[128:131], v[240:243]
    v_exp_f32 v166, v166
    v_mfma_f32_16x16x32_bf16 v[232:235], a[60:63], v[128:131], 0
    v_exp_f32 v167, v167
    v_mfma_f32_16x16x32_bf16 v[232:235], a[56:59], v[124:127], v[232:235]
    v_exp_f32 v168, v168
    v_mfma_f32_16x16x32_bf16 v[232:235], a[52:55], v[120:123], v[232:235]
    v_exp_f32 v169, v169
    v_mfma_f32_16x16x32_bf16 v[232:235], a[48:51], v[116:119], v[232:235]
    buffer_store_dwordx4 v[104:107], v246, s[12:15], s34 offen offset:2048 sc0 sc1
    v_cvt_pk_bf16_f32 v184, v164, v165
    v_mfma_f32_16x16x4_4b_bf16 v[200:215], v[108:109], v[188:189], 0
    v_exp_f32 v170, v170
    v_exp_f32 v171, v171
    v_cvt_pk_bf16_f32 v185, v166, v167
    v_cvt_pk_bf16_f32 v186, v168, v169
    v_cvt_pk_bf16_f32 v187, v170, v171
    v_cvt_pk_bf16_f32 v2, v236, v237
    v_smfmac_f32_16x16x64_bf16 v[172:175], v[112:115], v[176:183], v244
    s_add_u32 s34, s33, 0
    s_add_u32 s33, s33, 13107200
    v_cvt_pk_bf16_f32 v3, v238, v239
    v_smfmac_f32_16x16x64_bf16 v[172:175], v[110:113], v[184:191], v244
    s_add_u32 s14, s33, 25600
    v_cvt_pk_bf16_f32 v4, v240, v241
    v_mfma_f32_16x16x32_bf16 v[200:203], v[56:59], v[176:179], v[200:203]
    ds_read_b128 v[132:135], v245 offset:4352
    v_cvt_pk_bf16_f32 v5, v242, v243
    v_mfma_f32_16x16x32_bf16 v[200:203], v[72:75], v[180:183], v[200:203]
    ds_read_b128 v[136:139], v245 offset:4416
    ds_read_b128 v[140:143], v245 offset:4480
    v_mfma_f32_16x16x32_bf16 v[200:203], v[88:91], v[184:187], v[200:203]
    ds_read_b128 v[144:147], v245 offset:4544
    v_cvt_pk_bf16_f32 v6, v232, v233
    v_mfma_f32_16x16x32_bf16 v[204:207], v[92:95], v[184:187], v[204:207]
    ds_read_b128 v[48:51], v249 offset:16384
    v_cvt_pk_bf16_f32 v7, v234, v235
    v_mfma_f32_16x16x32_bf16 v[204:207], v[76:79], v[180:183], v[204:207]
    ds_read_b128 v[52:55], v249 offset:16400
    ds_read2_b64 v[192:195], v254 offset0:0 offset1:64
    v_mfma_f32_16x16x32_bf16 v[204:207], v[60:63], v[176:179], v[204:207]
    v_add_f32 v174, v174, v175
    v_mov_b64 v[172:173], 0
    v_mfma_f32_16x16x32_bf16 v[208:211], v[64:67], v[176:179], v[208:211]
    v_rcp_f32 v253, v174
    v_mfma_f32_16x16x32_bf16 v[208:211], v[80:83], v[180:183], v[208:211]
    v_maximum3_f32 v252, v252, v174, v253
    v_mov_b64 v[148:149], s[24:25]
    v_mfma_f32_16x16x32_bf16 v[208:211], v[96:99], v[184:187], v[208:211]
    v_mov_b64 v[150:151], s[24:25]
    v_mov_b64 v[152:153], s[24:25]
    v_mfma_f32_16x16x32_bf16 v[212:215], v[100:103], v[184:187], v[212:215]
    v_mov_b64 v[154:155], s[24:25]
    v_mov_b64 v[156:157], s[24:25]
    v_mfma_f32_16x16x32_bf16 v[212:215], v[84:87], v[180:183], v[212:215]
    v_mov_b64 v[158:159], s[24:25]
    v_and_b32 v161, -5, v255
    v_mfma_f32_16x16x32_bf16 v[212:215], v[68:71], v[176:179], v[212:215]
    s_waitcnt lgkmcnt(3)
    ds_read_b64 v[108:109], v251 offset:32768
    v_fma_f32 v200, v200, v253, v216
    v_mfma_f32_16x16x32_bf16 v[236:239], v[116:119], a[64:67], 0
    v_fma_f32 v201, v201, v253, v217
    v_fma_f32 v202, v202, v253, v218
    v_mfma_f32_16x16x32_bf16 v[236:239], v[120:123], a[68:71], v[236:239]
    s_nop 0
    v_fma_f32 v212, v212, v253, v228
    v_fma_f32 v213, v213, v253, v229
    v_mfma_f32_16x16x32_bf16 v[236:239], v[124:127], a[72:75], v[236:239]
    s_waitcnt lgkmcnt(1)
    v_mov_b32_dpp v196, v192 quad_perm:[2,3,0,1] row_mask:0xf bank_mask:0xf
    v_mov_b32_dpp v197, v193 quad_perm:[2,3,0,1] row_mask:0xf bank_mask:0xf
    v_mfma_f32_16x16x32_bf16 v[236:239], v[128:131], a[76:79], v[236:239]
    v_mov_b32_dpp v198, v194 quad_perm:[2,3,0,1] row_mask:0xf bank_mask:0xf
    v_mov_b32_dpp v199, v195 quad_perm:[2,3,0,1] row_mask:0xf bank_mask:0xf
    v_mfma_f32_16x16x32_bf16 v[240:243], v[128:131], a[92:95], 0
    v_fma_f32 v214, v214, v253, v230
    v_fma_f32 v215, v215, v253, v231
    v_mfma_f32_16x16x32_bf16 v[240:243], v[124:127], a[88:91], v[240:243]
    buffer_load_dwordx4 v248, s[8:11], s37 offen nt lds
    v_mfma_f32_16x16x32_bf16 v[240:243], v[120:123], a[84:87], v[240:243]
    s_addk_i32 m0, 2176
    v_cvt_pk_bf16_f32 v56, v236, v237
    v_cvt_pk_bf16_f32 v57, v238, v239
    v_mfma_f32_16x16x32_bf16 v[240:243], v[116:119], a[80:83], v[240:243]
    s_addk_i32 s37, 2048
    v_cvt_pk_bf16_f32 v106, v212, v213
    v_cvt_pk_bf16_f32 v107, v214, v215
    v_mfma_f32_16x16x32_bf16 v[232:235], v[116:119], a[96:99], 0
    s_waitcnt lgkmcnt(0)
    v_fma_f32 v203, v203, v253, v219
    v_cvt_pk_bf16_f32 v200, v200, v201
    v_mfma_f32_16x16x32_bf16 v[232:235], v[120:123], a[100:103], v[232:235]
    v_cvt_pk_bf16_f32 v60, v240, v241
    v_cvt_pk_bf16_f32 v61, v242, v243
    v_mfma_f32_16x16x32_bf16 v[232:235], v[124:127], a[104:107], v[232:235]
    v_fma_f32 v204, v204, v253, v220
    v_fma_f32 v205, v205, v253, v221
    v_mfma_f32_16x16x32_bf16 v[232:235], v[128:131], a[108:111], v[232:235]
    v_fma_f32 v206, v206, v253, v222
    v_fma_f32 v207, v207, v253, v223
    v_mfma_f32_16x16x32_bf16 v[236:239], v[128:131], a[124:127], 0
    s_nop 0
    ds_read_b128 v[128:131], v245 offset:8896
    v_cvt_pk_bf16_f32 v201, v202, v203
    v_mfma_f32_16x16x32_bf16 v[236:239], v[124:127], a[120:123], v[236:239]
    s_nop 0
    v_cvt_pk_bf16_f32 v64, v232, v233
    v_cvt_pk_bf16_f32 v65, v234, v235
    v_mfma_f32_16x16x32_bf16 v[236:239], v[120:123], a[116:119], v[236:239]
    ds_read_b128 v[120:123], v245 offset:8768
    ds_read_b128 v[124:127], v245 offset:8832
    v_mfma_f32_16x16x32_bf16 v[236:239], v[116:119], a[112:115], v[236:239]
    ds_read_b128 v[116:119], v245 offset:8704
    v_fma_f32 v208, v208, v253, v224
    v_mfma_f32_16x16x32_bf16 v[240:243], a[0:3], v[132:135], 0
    s_nop 0
    v_fma_f32 v209, v209, v253, v225
    v_fma_f32 v210, v210, v253, v226
    v_mfma_f32_16x16x32_bf16 v[240:243], a[4:7], v[136:139], v[240:243]
    s_nop 0
    v_cvt_pk_bf16_f32 v68, v236, v237
    v_cvt_pk_bf16_f32 v69, v238, v239
    v_mfma_f32_16x16x32_bf16 v[240:243], a[8:11], v[140:143], v[240:243]
    v_fma_f32 v211, v211, v253, v227
    v_cvt_pk_bf16_f32 v202, v204, v205
    v_mfma_f32_16x16x32_bf16 v[240:243], a[12:15], v[144:147], v[240:243]
    v_cvt_pk_bf16_f32 v203, v206, v207
    v_cvt_pk_bf16_f32 v104, v208, v209
    v_mfma_f32_16x16x32_bf16 v[232:235], a[28:31], v[144:147], 0
    s_nop 0
    v_cvt_pk_bf16_f32 v105, v210, v211
    v_cndmask_b32_dpp v204, v104, v200, vcc row_ror:8 row_mask:0xf bank_mask:0xf
    v_mfma_f32_16x16x32_bf16 v[232:235], a[24:27], v[140:143], v[232:235]
    s_nop 0
    v_cvt_pk_bf16_f32 v8, v240, v241
    v_cvt_pk_bf16_f32 v9, v242, v243
    v_mfma_f32_16x16x32_bf16 v[232:235], a[20:23], v[136:139], v[232:235]
    v_cndmask_b32_dpp v205, v105, v201, vcc row_ror:8 row_mask:0xf bank_mask:0xf
    v_cndmask_b32_dpp v206, v106, v202, vcc row_ror:8 row_mask:0xf bank_mask:0xf
    v_mfma_f32_16x16x32_bf16 v[232:235], a[16:19], v[132:135], v[232:235]
    v_cndmask_b32_dpp v207, v107, v203, vcc row_ror:8 row_mask:0xf bank_mask:0xf
    v_mov_b32_dpp v104, v200 row_ror:8 row_mask:0xf bank_mask:0x3
    v_mfma_f32_16x16x32_bf16 v[236:239], a[32:35], v[132:135], 0
    s_waitcnt lgkmcnt(0)
    v_mov_b32_dpp v105, v201 row_ror:8 row_mask:0xf bank_mask:0x3
    v_mov_b32_dpp v106, v202 row_ror:8 row_mask:0xf bank_mask:0x3
    v_mfma_f32_16x16x32_bf16 v[236:239], a[36:39], v[136:139], v[236:239]
    s_nop 0
    v_cvt_pk_bf16_f32 v10, v232, v233
    v_cvt_pk_bf16_f32 v11, v234, v235
    v_mfma_f32_16x16x32_bf16 v[236:239], a[40:43], v[140:143], v[236:239]
    v_mov_b32_dpp v107, v203 row_ror:8 row_mask:0xf bank_mask:0x3
    v_pk_max_i16 v204, v204, 0
    v_mfma_f32_16x16x32_bf16 v[236:239], a[44:47], v[144:147], v[236:239]
    v_pk_max_i16 v205, v205, 0
    v_pk_max_i16 v206, v206, 0
    v_mfma_f32_16x16x32_bf16 v[240:243], a[60:63], v[144:147], 0
    s_nop 0
    v_pk_max_i16 v207, v207, 0
    v_mov_b64 v[200:201], 0
    v_mfma_f32_16x16x32_bf16 v[240:243], a[56:59], v[140:143], v[240:243]
    s_nop 0
    v_cvt_pk_bf16_f32 v12, v236, v237
    v_cvt_pk_bf16_f32 v13, v238, v239
    v_mfma_f32_16x16x32_bf16 v[240:243], a[52:55], v[136:139], v[240:243]
    v_mov_b64 v[202:203], 0
    v_cmp_nge_f32 s[44:45], s42, v252
    v_mfma_f32_16x16x32_bf16 v[240:243], a[48:51], v[132:135], v[240:243]
    s_nop 0
    buffer_store_dwordx4 v[204:207], v246, s[12:15], s34 offen offset:0 sc0 sc1
    v_mov_b32 v252, 0
    v_pk_max_i16 v104, v104, 0
    v_mov_b64 v[204:205], 0
    v_mfma_f32_16x16x32_bf16 v[232:235], v[132:135], a[64:67], 0
    s_or_b32 s23, s44, s45
    v_mov_b64 v[206:207], 0
    v_cvt_pk_bf16_f32 v14, v240, v241
    v_mfma_f32_16x16x32_bf16 v[232:235], v[136:139], a[68:71], v[232:235]
    s_min_u32 s23, s23, 1
    v_cvt_pk_bf16_f32 v15, v242, v243
    v_pk_max_i16 v105, v105, 0
    v_mfma_f32_16x16x32_bf16 v[232:235], v[140:143], a[72:75], v[232:235]
    s_lshl1_add_u32 s40, s40, s23
    v_pk_max_i16 v106, v106, 0
    v_pk_max_i16 v107, v107, 0
    v_mfma_f32_16x16x32_bf16 v[232:235], v[144:147], a[76:79], v[232:235]
    buffer_load_dwordx4 v248, s[8:11], s37 offen nt lds
    v_mfma_f32_16x16x32_bf16 v[236:239], v[144:147], a[92:95], 0
    s_addk_i32 m0, 2176
    buffer_store_dwordx4 v[104:107], v246, s[12:15], s34 offen offset:2048 sc0 sc1
    v_add_u32 v254, 128, v254
    v_add_u32 v249, 128, v249
    v_bfe_u32 v104, v246, 8, 3
    v_mfma_f32_16x16x32_bf16 v[236:239], v[140:143], a[88:91], v[236:239]
    s_addk_i32 s37, 2048
    v_cvt_pk_bf16_f32 v58, v232, v233
    v_cvt_pk_bf16_f32 v59, v234, v235
    v_mfma_f32_16x16x32_bf16 v[236:239], v[136:139], a[84:87], v[236:239]
    s_add_u32 s34, s33, 24576
    v_lshl_add_u32 v104, v104, 3, v246
    v_add_u32 v104, s22, v104
    v_mfma_f32_16x16x32_bf16 v[236:239], v[132:135], a[80:83], v[236:239]
    v_add_u32 v251, 512, v251
    s_nop 0
    v_mfma_f32_16x16x32_bf16 v[240:243], v[132:135], a[96:99], 0
    s_nop 2
    v_mfma_f32_16x16x32_bf16 v[240:243], v[136:139], a[100:103], v[240:243]
    s_nop 0
    v_cvt_pk_bf16_f32 v62, v236, v237
    v_cvt_pk_bf16_f32 v63, v238, v239
    v_mfma_f32_16x16x32_bf16 v[240:243], v[140:143], a[104:107], v[240:243]
    v_mfma_f32_16x16x32_bf16 v[240:243], v[144:147], a[108:111], v[240:243]
    s_nop 1
    v_mfma_f32_16x16x32_bf16 v[232:235], v[144:147], a[124:127], 0
    s_nop 0
    ds_read_b128 v[144:147], v245 offset:13248
    s_nop 0
    v_mfma_f32_16x16x32_bf16 v[232:235], v[140:143], a[120:123], v[232:235]
    s_nop 0
    v_cvt_pk_bf16_f32 v66, v240, v241
    v_cvt_pk_bf16_f32 v67, v242, v243
    v_mfma_f32_16x16x32_bf16 v[232:235], v[136:139], a[116:119], v[232:235]
    ds_read_b128 v[136:139], v245 offset:13120
    ds_read_b128 v[140:143], v245 offset:13184
    v_mfma_f32_16x16x32_bf16 v[232:235], v[132:135], a[112:115], v[232:235]
    ds_read_b128 v[132:135], v245 offset:13056
    s_nop 0
    v_mfma_f32_16x16x32_bf16 v[236:239], a[0:3], v[116:119], 0
    s_nop 2
    v_mfma_f32_16x16x32_bf16 v[236:239], a[4:7], v[120:123], v[236:239]
    s_nop 0
    v_cvt_pk_bf16_f32 v70, v232, v233
    v_cvt_pk_bf16_f32 v71, v234, v235
    v_mfma_f32_16x16x32_bf16 v[236:239], a[8:11], v[124:127], v[236:239]
    v_mfma_f32_16x16x32_bf16 v[236:239], a[12:15], v[128:131], v[236:239]
    s_nop 1
    v_mfma_f32_16x16x32_bf16 v[240:243], a[28:31], v[128:131], 0
    s_nop 2
    v_mfma_f32_16x16x32_bf16 v[240:243], a[24:27], v[124:127], v[240:243]
    s_nop 0
    v_cvt_pk_bf16_f32 v16, v236, v237
    v_cvt_pk_bf16_f32 v17, v238, v239
    v_mfma_f32_16x16x32_bf16 v[240:243], a[20:23], v[120:123], v[240:243]
    v_mfma_f32_16x16x32_bf16 v[240:243], a[16:19], v[116:119], v[240:243]
    s_nop 1
    v_mfma_f32_16x16x32_bf16 v[232:235], a[32:35], v[116:119], 0
    s_waitcnt lgkmcnt(0)
    s_nop 1
    v_mfma_f32_16x16x32_bf16 v[232:235], a[36:39], v[120:123], v[232:235]
    s_nop 0
    v_cvt_pk_bf16_f32 v18, v240, v241
    v_cvt_pk_bf16_f32 v19, v242, v243
    v_mfma_f32_16x16x32_bf16 v[232:235], a[40:43], v[124:127], v[232:235]
    v_mfma_f32_16x16x32_bf16 v[232:235], a[44:47], v[128:131], v[232:235]
    s_nop 1
    v_mfma_f32_16x16x32_bf16 v[236:239], a[60:63], v[128:131], 0
    s_nop 2
    v_mfma_f32_16x16x32_bf16 v[236:239], a[56:59], v[124:127], v[236:239]
    s_nop 0
    v_cvt_pk_bf16_f32 v20, v232, v233
    v_cvt_pk_bf16_f32 v21, v234, v235
    v_mfma_f32_16x16x32_bf16 v[236:239], a[52:55], v[120:123], v[236:239]
    v_mfma_f32_16x16x32_bf16 v[236:239], a[48:51], v[116:119], v[236:239]
    s_nop 1
    v_mfma_f32_16x16x32_bf16 v[240:243], v[116:119], a[64:67], 0
    s_nop 2
    v_mfma_f32_16x16x32_bf16 v[240:243], v[120:123], a[68:71], v[240:243]
    s_nop 0
    v_cvt_pk_bf16_f32 v22, v236, v237
    v_cvt_pk_bf16_f32 v23, v238, v239
    v_mfma_f32_16x16x32_bf16 v[240:243], v[124:127], a[72:75], v[240:243]
    buffer_load_dwordx4 v248, s[8:11], s37 offen nt lds
    v_mfma_f32_16x16x32_bf16 v[240:243], v[128:131], a[76:79], v[240:243]
    s_addk_i32 m0, 2176
    s_addk_i32 s37, 2048
    v_mfma_f32_16x16x32_bf16 v[232:235], v[128:131], a[92:95], 0
    s_nop 2
    v_mfma_f32_16x16x32_bf16 v[232:235], v[124:127], a[88:91], v[232:235]
    s_nop 0
    v_cvt_pk_bf16_f32 v72, v240, v241
    v_cvt_pk_bf16_f32 v73, v242, v243
    v_mfma_f32_16x16x32_bf16 v[232:235], v[120:123], a[84:87], v[232:235]
    v_mfma_f32_16x16x32_bf16 v[232:235], v[116:119], a[80:83], v[232:235]
    s_nop 1
    v_mfma_f32_16x16x32_bf16 v[236:239], v[116:119], a[96:99], 0
    s_nop 2
    v_mfma_f32_16x16x32_bf16 v[236:239], v[120:123], a[100:103], v[236:239]
    s_nop 0
    v_cvt_pk_bf16_f32 v76, v232, v233
    v_cvt_pk_bf16_f32 v77, v234, v235
    v_mfma_f32_16x16x32_bf16 v[236:239], v[124:127], a[104:107], v[236:239]
    v_mfma_f32_16x16x32_bf16 v[236:239], v[128:131], a[108:111], v[236:239]
    s_nop 1
    v_mfma_f32_16x16x32_bf16 v[240:243], v[128:131], a[124:127], 0
    s_nop 0
    ds_read_b128 v[128:131], v245 offset:17600
    s_nop 0
    v_mfma_f32_16x16x32_bf16 v[240:243], v[124:127], a[120:123], v[240:243]
    s_nop 0
    v_cvt_pk_bf16_f32 v80, v236, v237
    v_cvt_pk_bf16_f32 v81, v238, v239
    v_mfma_f32_16x16x32_bf16 v[240:243], v[120:123], a[116:119], v[240:243]
    ds_read_b128 v[120:123], v245 offset:17472
    ds_read_b128 v[124:127], v245 offset:17536
    v_mfma_f32_16x16x32_bf16 v[240:243], v[116:119], a[112:115], v[240:243]
    ds_read_b128 v[116:119], v245 offset:17408
    s_nop 0
    v_mfma_f32_16x16x32_bf16 v[232:235], a[0:3], v[132:135], 0
    s_nop 2
    v_mfma_f32_16x16x32_bf16 v[232:235], a[4:7], v[136:139], v[232:235]
    s_nop 0
    v_cvt_pk_bf16_f32 v84, v240, v241
    v_cvt_pk_bf16_f32 v85, v242, v243
    v_mfma_f32_16x16x32_bf16 v[232:235], a[8:11], v[140:143], v[232:235]
    v_mfma_f32_16x16x32_bf16 v[232:235], a[12:15], v[144:147], v[232:235]
    s_nop 1
    v_mfma_f32_16x16x32_bf16 v[236:239], a[28:31], v[144:147], 0
    s_nop 2
    v_mfma_f32_16x16x32_bf16 v[236:239], a[24:27], v[140:143], v[236:239]
    s_nop 0
    v_cvt_pk_bf16_f32 v24, v232, v233
    v_cvt_pk_bf16_f32 v25, v234, v235
    v_mfma_f32_16x16x32_bf16 v[236:239], a[20:23], v[136:139], v[236:239]
    v_mfma_f32_16x16x32_bf16 v[236:239], a[16:19], v[132:135], v[236:239]
    s_nop 1
    v_mfma_f32_16x16x32_bf16 v[240:243], a[32:35], v[132:135], 0
    s_waitcnt lgkmcnt(0)
    s_nop 1
    v_mfma_f32_16x16x32_bf16 v[240:243], a[36:39], v[136:139], v[240:243]
    s_nop 0
    v_cvt_pk_bf16_f32 v26, v236, v237
    v_cvt_pk_bf16_f32 v27, v238, v239
    v_mfma_f32_16x16x32_bf16 v[240:243], a[40:43], v[140:143], v[240:243]
    v_mfma_f32_16x16x32_bf16 v[240:243], a[44:47], v[144:147], v[240:243]
    s_nop 1
    v_mfma_f32_16x16x32_bf16 v[232:235], a[60:63], v[144:147], 0
    s_nop 2
    v_mfma_f32_16x16x32_bf16 v[232:235], a[56:59], v[140:143], v[232:235]
    s_nop 0
    v_cvt_pk_bf16_f32 v28, v240, v241
    v_cvt_pk_bf16_f32 v29, v242, v243
    v_mfma_f32_16x16x32_bf16 v[232:235], a[52:55], v[136:139], v[232:235]
    v_mfma_f32_16x16x32_bf16 v[232:235], a[48:51], v[132:135], v[232:235]
    v_mfma_f32_16x16x32_bf16 v[236:239], v[132:135], a[64:67], 0
    s_nop 1
    v_mfma_f32_16x16x32_bf16 v[236:239], v[136:139], a[68:71], v[236:239]
    s_nop 0
    buffer_load_dwordx4 v248, s[8:11], s37 offen nt lds
    v_mfma_f32_16x16x32_bf16 v[236:239], v[140:143], a[72:75], v[236:239]
    s_addk_i32 m0, 2176
    v_cvt_pk_bf16_f32 v30, v232, v233
    v_cvt_pk_bf16_f32 v31, v234, v235
    v_mfma_f32_16x16x32_bf16 v[236:239], v[144:147], a[76:79], v[236:239]
    s_addk_i32 s37, 2048
    s_nop 0
    v_mfma_f32_16x16x32_bf16 v[240:243], v[144:147], a[92:95], 0
    s_nop 2
    v_mfma_f32_16x16x32_bf16 v[240:243], v[140:143], a[88:91], v[240:243]
    s_nop 0
    v_cvt_pk_bf16_f32 v74, v236, v237
    v_cvt_pk_bf16_f32 v75, v238, v239
    v_mfma_f32_16x16x32_bf16 v[240:243], v[136:139], a[84:87], v[240:243]
    v_mfma_f32_16x16x32_bf16 v[240:243], v[132:135], a[80:83], v[240:243]
    s_nop 1
    v_mfma_f32_16x16x32_bf16 v[232:235], v[132:135], a[96:99], 0
    s_nop 2
    v_mfma_f32_16x16x32_bf16 v[232:235], v[136:139], a[100:103], v[232:235]
    s_nop 0
    v_cvt_pk_bf16_f32 v78, v240, v241
    v_cvt_pk_bf16_f32 v79, v242, v243
    v_mfma_f32_16x16x32_bf16 v[232:235], v[140:143], a[104:107], v[232:235]
    v_mfma_f32_16x16x32_bf16 v[232:235], v[144:147], a[108:111], v[232:235]
    s_nop 1
    v_mfma_f32_16x16x32_bf16 v[236:239], v[144:147], a[124:127], 0
    s_nop 0
    ds_read_b128 v[144:147], v245 offset:21952
    s_nop 0
    v_mfma_f32_16x16x32_bf16 v[236:239], v[140:143], a[120:123], v[236:239]
    s_nop 0
    v_cvt_pk_bf16_f32 v82, v232, v233
    v_cvt_pk_bf16_f32 v83, v234, v235
    v_mfma_f32_16x16x32_bf16 v[236:239], v[136:139], a[116:119], v[236:239]
    ds_read_b128 v[136:139], v245 offset:21824
    ds_read_b128 v[140:143], v245 offset:21888
    v_mfma_f32_16x16x32_bf16 v[236:239], v[132:135], a[112:115], v[236:239]
    ds_read_b128 v[132:135], v245 offset:21760
    s_nop 0
    v_mfma_f32_16x16x32_bf16 v[240:243], a[0:3], v[116:119], 0
    s_nop 2
    v_mfma_f32_16x16x32_bf16 v[240:243], a[4:7], v[120:123], v[240:243]
    s_nop 0
    v_cvt_pk_bf16_f32 v86, v236, v237
    v_cvt_pk_bf16_f32 v87, v238, v239
    v_mfma_f32_16x16x32_bf16 v[240:243], a[8:11], v[124:127], v[240:243]
    v_mfma_f32_16x16x32_bf16 v[240:243], a[12:15], v[128:131], v[240:243]
    s_nop 1
    v_mfma_f32_16x16x32_bf16 v[232:235], a[28:31], v[128:131], 0
    s_nop 2
    v_mfma_f32_16x16x32_bf16 v[232:235], a[24:27], v[124:127], v[232:235]
    s_nop 0
    v_cvt_pk_bf16_f32 v32, v240, v241
    v_cvt_pk_bf16_f32 v33, v242, v243
    v_mfma_f32_16x16x32_bf16 v[232:235], a[20:23], v[120:123], v[232:235]
    v_mfma_f32_16x16x32_bf16 v[232:235], a[16:19], v[116:119], v[232:235]
    s_nop 1
    v_mfma_f32_16x16x32_bf16 v[236:239], a[32:35], v[116:119], 0
    s_waitcnt lgkmcnt(0)
    s_nop 1
    v_mfma_f32_16x16x32_bf16 v[236:239], a[36:39], v[120:123], v[236:239]
    s_nop 0
    v_cvt_pk_bf16_f32 v34, v232, v233
    v_cvt_pk_bf16_f32 v35, v234, v235
    v_mfma_f32_16x16x32_bf16 v[236:239], a[40:43], v[124:127], v[236:239]
    v_mfma_f32_16x16x32_bf16 v[236:239], a[44:47], v[128:131], v[236:239]
    s_nop 1
    v_mfma_f32_16x16x32_bf16 v[240:243], a[60:63], v[128:131], 0
    s_nop 2
    v_mfma_f32_16x16x32_bf16 v[240:243], a[56:59], v[124:127], v[240:243]
    s_nop 0
    v_cvt_pk_bf16_f32 v36, v236, v237
    v_cvt_pk_bf16_f32 v37, v238, v239
    v_mfma_f32_16x16x32_bf16 v[240:243], a[52:55], v[120:123], v[240:243]
    v_mfma_f32_16x16x32_bf16 v[240:243], a[48:51], v[116:119], v[240:243]
    s_nop 2
    v_mfma_f32_16x16x32_bf16 v[232:235], v[116:119], a[64:67], 0
    s_nop 0
    buffer_load_dwordx4 v248, s[8:11], s37 offen nt lds
    v_mfma_f32_16x16x32_bf16 v[232:235], v[120:123], a[68:71], v[232:235]
    s_addk_i32 m0, 2176
    v_cvt_pk_bf16_f32 v38, v240, v241
    v_cvt_pk_bf16_f32 v39, v242, v243
    v_mfma_f32_16x16x32_bf16 v[232:235], v[124:127], a[72:75], v[232:235]
    s_addk_i32 s37, 2048
    v_mfma_f32_16x16x32_bf16 v[232:235], v[128:131], a[76:79], v[232:235]
    s_nop 1
    v_mfma_f32_16x16x32_bf16 v[236:239], v[128:131], a[92:95], 0
    s_nop 2
    v_mfma_f32_16x16x32_bf16 v[236:239], v[124:127], a[88:91], v[236:239]
    s_nop 0
    v_cvt_pk_bf16_f32 v88, v232, v233
    v_cvt_pk_bf16_f32 v89, v234, v235
    v_mfma_f32_16x16x32_bf16 v[236:239], v[120:123], a[84:87], v[236:239]
    v_mfma_f32_16x16x32_bf16 v[236:239], v[116:119], a[80:83], v[236:239]
    s_nop 1
    v_mfma_f32_16x16x32_bf16 v[240:243], v[116:119], a[96:99], 0
    s_nop 2
    v_mfma_f32_16x16x32_bf16 v[240:243], v[120:123], a[100:103], v[240:243]
    s_nop 0
    v_cvt_pk_bf16_f32 v92, v236, v237
    v_cvt_pk_bf16_f32 v93, v238, v239
    v_mfma_f32_16x16x32_bf16 v[240:243], v[124:127], a[104:107], v[240:243]
    v_mfma_f32_16x16x32_bf16 v[240:243], v[128:131], a[108:111], v[240:243]
    s_nop 1
    v_mfma_f32_16x16x32_bf16 v[232:235], v[128:131], a[124:127], 0
    s_nop 2
    v_mfma_f32_16x16x32_bf16 v[232:235], v[124:127], a[120:123], v[232:235]
    s_nop 0
    v_cvt_pk_bf16_f32 v96, v240, v241
    v_cvt_pk_bf16_f32 v97, v242, v243
    v_mfma_f32_16x16x32_bf16 v[232:235], v[120:123], a[116:119], v[232:235]
    v_mfma_f32_16x16x32_bf16 v[232:235], v[116:119], a[112:115], v[232:235]
    s_branch L_mid
.p2align 12
L_pad3:
    s_branch L_touched2
L_tail:
    s_cmp_eq_u32 s32, 4
    s_cbranch_scc1 L_tail4
    s_mov_b32 s46, m0
    s_add_u32 m0, s52, 60928
    s_add_u32 s47, s53, 52453376
    buffer_load_dwordx4 v248, s[8:11], s47 offen nt lds
    s_add_u32 m0, s52, 62016
    s_add_u32 s47, s53, 65560576
    buffer_load_dwordx4 v248, s[8:11], s47 offen nt lds
    s_mov_b32 m0, s46
    s_branch L_body
L_tail4:
    v_add_u32 v16, s43, v245
    ds_read_b128 v[0:3], v16 offset:0
    ds_read_b128 v[4:7], v16 offset:64
    ds_read_b128 v[8:11], v16 offset:128
    ds_read_b128 v[12:15], v16 offset:192
    v_mbcnt_lo_u32_b32 v48, -1, 0
    v_mbcnt_hi_u32_b32 v48, -1, v48
    v_lshl_add_u32 v49, v48, 4, s57
    v_lshl_add_u32 v48, v48, 5, s57
    v_subrev_u32 v249, 512, v249
    v_subrev_u32 v250, 256, v250
    v_subrev_u32 v254, 512, v254
    v_subrev_u32 v251, 2048, v251
    s_waitcnt lgkmcnt(0)
    v_mfma_f32_16x16x32_bf16 v[32:35], a[192:195], v[0:3], 0
    v_mfma_f32_16x16x32_bf16 v[32:35], a[196:199], v[4:7], v[32:35]
    v_mfma_f32_16x16x32_bf16 v[32:35], a[200:203], v[8:11], v[32:35]
    v_mfma_f32_16x16x32_bf16 v[32:35], a[204:207], v[12:15], v[32:35]
    s_nop 1
    v_mfma_f32_16x16x32_bf16 v[36:39], a[220:223], v[12:15], 0
    s_nop 2
    v_mfma_f32_16x16x32_bf16 v[36:39], a[216:219], v[8:11], v[36:39]
    s_nop 0
    ds_write_b128 v49, v[32:35] offset:0
    v_mfma_f32_16x16x32_bf16 v[36:39], a[212:215], v[4:7], v[36:39]
    v_mfma_f32_16x16x32_bf16 v[36:39], a[208:211], v[0:3], v[36:39]
    s_nop 1
    v_mfma_f32_16x16x32_bf16 v[40:43], a[224:227], v[0:3], 0
    s_nop 2
    v_mfma_f32_16x16x32_bf16 v[40:43], a[228:231], v[4:7], v[40:43]
    s_nop 0
    ds_write_b128 v49, v[36:39] offset:8192
    v_mfma_f32_16x16x32_bf16 v[40:43], a[232:235], v[8:11], v[40:43]
    v_mfma_f32_16x16x32_bf16 v[40:43], a[236:239], v[12:15], v[40:43]
    s_nop 1
    v_mfma_f32_16x16x32_bf16 v[44:47], a[252:255], v[12:15], 0
    s_nop 2
    v_mfma_f32_16x16x32_bf16 v[44:47], a[248:251], v[8:11], v[44:47]
    s_nop 0
    ds_write_b128 v49, v[40:43] offset:1024
    v_mfma_f32_16x16x32_bf16 v[44:47], a[244:247], v[4:7], v[44:47]
    v_mfma_f32_16x16x32_bf16 v[44:47], a[240:243], v[0:3], v[44:47]
    s_nop 1
    v_mfma_f32_16x16x32_bf16 v[232:235], a[0:3], v[0:3], 0
    s_nop 2
    v_mfma_f32_16x16x32_bf16 v[232:235], a[4:7], v[4:7], v[232:235]
    s_nop 0
    ds_write_b128 v49, v[44:47] offset:9216
    v_mfma_f32_16x16x32_bf16 v[232:235], a[8:11], v[8:11], v[232:235]
    v_mfma_f32_16x16x32_bf16 v[232:235], a[12:15], v[12:15], v[232:235]
    s_nop 1
    v_mfma_f32_16x16x32_bf16 v[236:239], a[28:31], v[12:15], 0
    s_nop 2
    v_mfma_f32_16x16x32_bf16 v[236:239], a[24:27], v[8:11], v[236:239]
    s_nop 0
    v_cvt_pk_bf16_f32 v16, v232, v233
    v_cvt_pk_bf16_f32 v17, v234, v235
    v_mfma_f32_16x16x32_bf16 v[236:239], a[20:23], v[4:7], v[236:239]
    v_mfma_f32_16x16x32_bf16 v[236:239], a[16:19], v[0:3], v[236:239]
    s_nop 1
    v_mfma_f32_16x16x32_bf16 v[240:243], a[32:35], v[0:3], 0
    s_nop 2
    v_mfma_f32_16x16x32_bf16 v[240:243], a[36:39], v[4:7], v[240:243]
    s_nop 0
    v_cvt_pk_bf16_f32 v18, v236, v237
    v_cvt_pk_bf16_f32 v19, v238, v239
    v_mfma_f32_16x16x32_bf16 v[240:243], a[40:43], v[8:11], v[240:243]
    ds_write_b128 v48, v[16:19] offset:16384
    v_mfma_f32_16x16x32_bf16 v[240:243], a[44:47], v[12:15], v[240:243]
    s_nop 1
    v_mfma_f32_16x16x32_bf16 v[232:235], a[60:63], v[12:15], 0
    s_nop 2
    v_mfma_f32_16x16x32_bf16 v[232:235], a[56:59], v[8:11], v[232:235]
    s_nop 0
    v_cvt_pk_bf16_f32 v20, v240, v241
    v_cvt_pk_bf16_f32 v21, v242, v243
    v_mfma_f32_16x16x32_bf16 v[232:235], a[52:55], v[4:7], v[232:235]
    v_mfma_f32_16x16x32_bf16 v[232:235], a[48:51], v[0:3], v[232:235]
    s_nop 1
    v_mfma_f32_16x16x32_bf16 v[236:239], a[128:131], v[0:3], 0
    s_nop 2
    v_mfma_f32_16x16x32_bf16 v[236:239], a[132:135], v[4:7], v[236:239]
    s_nop 0
    v_cvt_pk_bf16_f32 v22, v232, v233
    v_cvt_pk_bf16_f32 v23, v234, v235
    v_mfma_f32_16x16x32_bf16 v[236:239], a[136:139], v[8:11], v[236:239]
    ds_write_b128 v48, v[20:23] offset:16400
    v_mfma_f32_16x16x32_bf16 v[236:239], a[140:143], v[12:15], v[236:239]
    s_nop 1
    v_mfma_f32_16x16x32_bf16 v[240:243], a[156:159], v[12:15], 0
    s_nop 2
    v_mfma_f32_16x16x32_bf16 v[240:243], a[152:155], v[8:11], v[240:243]
    s_nop 0
    v_cvt_pk_bf16_f32 v24, v236, v237
    v_cvt_pk_bf16_f32 v26, v238, v239
    v_mfma_f32_16x16x32_bf16 v[240:243], a[148:151], v[4:7], v[240:243]
    v_mfma_f32_16x16x32_bf16 v[240:243], a[144:147], v[0:3], v[240:243]
    s_nop 1
    v_mfma_f32_16x16x32_bf16 v[232:235], a[160:163], v[0:3], 0
    s_nop 2
    v_mfma_f32_16x16x32_bf16 v[232:235], a[164:167], v[4:7], v[232:235]
    s_nop 0
    v_cvt_pk_bf16_f32 v25, v240, v241
    v_cvt_pk_bf16_f32 v27, v242, v243
    v_mfma_f32_16x16x32_bf16 v[232:235], a[168:171], v[8:11], v[232:235]
    ds_write_b128 v48, v[24:27] offset:24576
    v_mfma_f32_16x16x32_bf16 v[232:235], a[172:175], v[12:15], v[232:235]
    s_nop 1
    v_mfma_f32_16x16x32_bf16 v[236:239], a[188:191], v[12:15], 0
    s_nop 2
    v_mfma_f32_16x16x32_bf16 v[236:239], a[184:187], v[8:11], v[236:239]
    s_nop 0
    v_cvt_pk_bf16_f32 v28, v232, v233
    v_cvt_pk_bf16_f32 v30, v234, v235
    v_mfma_f32_16x16x32_bf16 v[236:239], a[180:183], v[4:7], v[236:239]
    v_mfma_f32_16x16x32_bf16 v[236:239], a[176:179], v[0:3], v[236:239]
    s_nop 1
    v_mfma_f32_16x16x32_bf16 v[240:243], v[0:3], a[64:67], 0
    s_nop 2
    v_mfma_f32_16x16x32_bf16 v[240:243], v[4:7], a[68:71], v[240:243]
    s_nop 0
    v_cvt_pk_bf16_f32 v29, v236, v237
    v_cvt_pk_bf16_f32 v31, v238, v239
    v_mfma_f32_16x16x32_bf16 v[240:243], v[8:11], a[72:75], v[240:243]
    ds_write_b128 v48, v[28:31] offset:24592
    v_mfma_f32_16x16x32_bf16 v[240:243], v[12:15], a[76:79], v[240:243]
    s_nop 1
    v_mfma_f32_16x16x32_bf16 v[232:235], v[12:15], a[92:95], 0
    s_nop 2
    v_mfma_f32_16x16x32_bf16 v[232:235], v[8:11], a[88:91], v[232:235]
    s_nop 0
    v_mul_f32 v240, s41, v240
    v_mul_f32 v241, s41, v241
    v_mfma_f32_16x16x32_bf16 v[232:235], v[4:7], a[84:87], v[232:235]
    v_mul_f32 v242, s41, v242
    v_mul_f32 v243, s41, v243
    v_mfma_f32_16x16x32_bf16 v[232:235], v[0:3], a[80:83], v[232:235]
    v_cvt_pk_bf16_f32 v16, v240, v241
    v_cvt_pk_bf16_f32 v17, v242, v243
    v_mfma_f32_16x16x32_bf16 v[236:239], v[0:3], a[96:99], 0
    s_nop 2
    v_mfma_f32_16x16x32_bf16 v[236:239], v[4:7], a[100:103], v[236:239]
    s_nop 0
    v_mul_f32 v232, s41, v232
    v_mul_f32 v233, s41, v233
    v_mfma_f32_16x16x32_bf16 v[236:239], v[8:11], a[104:107], v[236:239]
    v_mul_f32 v234, s41, v234
    v_mul_f32 v235, s41, v235
    v_mfma_f32_16x16x32_bf16 v[236:239], v[12:15], a[108:111], v[236:239]
    s_nop 0
    v_cvt_pk_bf16_f32 v18, v232, v233
    v_cvt_pk_bf16_f32 v19, v234, v235
    v_mfma_f32_16x16x32_bf16 v[240:243], v[12:15], a[124:127], 0
    s_nop 0
    ds_write_b128 v48, v[16:19] offset:32768
    v_mfma_f32_16x16x32_bf16 v[240:243], v[8:11], a[120:123], v[240:243]
    s_nop 0
    v_mul_f32 v236, s41, v236
    v_mul_f32 v237, s41, v237
    v_mfma_f32_16x16x32_bf16 v[240:243], v[4:7], a[116:119], v[240:243]
    v_mul_f32 v238, s41, v238
    v_mul_f32 v239, s41, v239
    v_mfma_f32_16x16x32_bf16 v[240:243], v[0:3], a[112:115], v[240:243]
    s_nop 0
    v_cvt_pk_bf16_f32 v20, v236, v237
    v_cvt_pk_bf16_f32 v21, v238, v239
    s_nop 4
    v_mul_f32 v240, s41, v240
    v_mul_f32 v241, s41, v241
    v_mul_f32 v242, s41, v242
    v_mul_f32 v243, s41, v243
    v_cvt_pk_bf16_f32 v22, v240, v241
    v_cvt_pk_bf16_f32 v23, v242, v243
    ds_write_b128 v48, v[20:23] offset:32784
    s_branch L_body
L_pad4:
    s_branch L_touched2
L_side:
    s_cmp_eq_u64 s[54:55], 0
    s_cbranch_scc1 L_fresh
    s_mov_b32 s46, m0
    s_mov_b32 m0, s7
    s_waitcnt lgkmcnt(0)
L_retry:
    ds_read_addtid_b32 v116
    s_waitcnt lgkmcnt(0)
    v_cmp_ne_u32 s[54:55], v116, v245
    s_nop 1
    s_cmp_lg_u64 s[54:55], 0
    s_cbranch_scc1 L_retry
    s_mov_b32 m0, s46
    ds_read_b128 v[120:123], v245 offset:64
    ds_read_b128 v[116:119], v245 offset:0
    ds_read_b128 v[124:127], v245 offset:128
    ds_read_b128 v[128:131], v245 offset:192
    s_waitcnt lgkmcnt(0)
    s_bitcmp0_b32 0x118, s32
    s_cbranch_scc1 L_body
L_fresh:
    s_cmp_lt_u32 s32, 8
    s_cbranch_scc1 L_tail
    v_mfma_f32_16x16x4_4b_bf16 v[200:215], v[108:109], v[188:189], 0
    v_exp_f32 v161, v161
    v_exp_f32 v162, v162
    v_exp_f32 v163, v163
    v_cvt_pk_bf16_f32 v176, v148, v149
    v_cvt_pk_bf16_f32 v177, v150, v151
    v_cvt_pk_bf16_f32 v178, v152, v153
    v_cvt_pk_bf16_f32 v179, v154, v155
    v_cvt_pk_bf16_f32 v180, v156, v157
    v_cvt_pk_bf16_f32 v181, v158, v159
    v_cvt_pk_bf16_f32 v182, v160, v161
    v_cvt_pk_bf16_f32 v183, v162, v163
    v_exp_f32 v164, v164
    v_exp_f32 v165, v165
    v_smfmac_f32_16x16x64_bf16 v[172:175], v[112:115], v[176:183], v244
    v_cvt_pk_bf16_f32 v184, v164, v165
    v_exp_f32 v166, v166
    v_exp_f32 v167, v167
    v_exp_f32 v168, v168
    v_exp_f32 v169, v169
    v_exp_f32 v170, v170
    v_exp_f32 v171, v171
    v_cvt_pk_bf16_f32 v185, v166, v167
    v_cvt_pk_bf16_f32 v186, v168, v169
    v_cvt_pk_bf16_f32 v187, v170, v171
    buffer_store_dwordx4 v[104:107], v246, s[12:15], s34 offen offset:2048 sc0 sc1
    s_nop 0
    v_smfmac_f32_16x16x64_bf16 v[172:175], v[110:113], v[184:191], v244
    s_add_u32 s34, s33, 0
    s_add_u32 s33, s33, 13107200
    s_add_u32 s14, s33, 25600
    v_mfma_f32_16x16x32_bf16 v[200:203], v[56:59], v[176:179], v[200:203]
    s_nop 1
    v_mfma_f32_16x16x32_bf16 v[200:203], v[72:75], v[180:183], v[200:203]
    s_nop 0
    v_add_f32 v174, v174, v175
    v_mfma_f32_16x16x32_bf16 v[200:203], v[88:91], v[184:187], v[200:203]
    s_nop 0
    v_rcp_f32 v253, v174
    v_mfma_f32_16x16x32_bf16 v[204:207], v[92:95], v[184:187], v[204:207]
    s_nop 0
    v_maximum3_f32 v252, v252, v174, v253
    v_cmp_nge_f32 s[44:45], s42, v252
    v_mfma_f32_16x16x32_bf16 v[204:207], v[76:79], v[180:183], v[204:207]
    s_nop 0
    v_fma_f32 v200, v200, v253, v216
    v_fma_f32 v201, v201, v253, v217
    v_mfma_f32_16x16x32_bf16 v[204:207], v[60:63], v[176:179], v[204:207]
    s_or_b32 s23, s44, s45
    v_fma_f32 v202, v202, v253, v218
    v_fma_f32 v203, v203, v253, v219
    v_mfma_f32_16x16x32_bf16 v[208:211], v[64:67], v[176:179], v[208:211]
    s_min_u32 s23, s23, 1
    v_cvt_pk_bf16_f32 v200, v200, v201
    v_cvt_pk_bf16_f32 v201, v202, v203
    v_mfma_f32_16x16x32_bf16 v[208:211], v[80:83], v[180:183], v[208:211]
    s_lshl1_add_u32 s40, s40, s23
    v_fma_f32 v204, v204, v253, v220
    v_fma_f32 v205, v205, v253, v221
    v_mfma_f32_16x16x32_bf16 v[208:211], v[96:99], v[184:187], v[208:211]
    v_fma_f32 v206, v206, v253, v222
    v_fma_f32 v207, v207, v253, v223
    v_mfma_f32_16x16x32_bf16 v[212:215], v[100:103], v[184:187], v[212:215]
    s_nop 0
    v_cvt_pk_bf16_f32 v202, v204, v205
    v_cvt_pk_bf16_f32 v203, v206, v207
    v_mfma_f32_16x16x32_bf16 v[212:215], v[84:87], v[180:183], v[212:215]
    s_nop 0
    v_fma_f32 v208, v208, v253, v224
    v_fma_f32 v209, v209, v253, v225
    v_mfma_f32_16x16x32_bf16 v[212:215], v[68:71], v[176:179], v[212:215]
    s_nop 0
    v_fma_f32 v210, v210, v253, v226
    v_fma_f32 v211, v211, v253, v227
    v_cvt_pk_bf16_f32 v104, v208, v209
    v_cvt_pk_bf16_f32 v105, v210, v211
    v_mov_b32 v252, 0
    v_cndmask_b32_dpp v204, v104, v200, vcc row_ror:8 row_mask:0xf bank_mask:0xf
    v_cndmask_b32_dpp v205, v105, v201, vcc row_ror:8 row_mask:0xf bank_mask:0xf
    v_fma_f32 v212, v212, v253, v228
    v_fma_f32 v213, v213, v253, v229
    v_fma_f32 v214, v214, v253, v230
    v_fma_f32 v215, v215, v253, v231
    v_cvt_pk_bf16_f32 v106, v212, v213
    v_cvt_pk_bf16_f32 v107, v214, v215
    v_pk_max_i16 v204, v204, 0
    v_cndmask_b32_dpp v206, v106, v202, vcc row_ror:8 row_mask:0xf bank_mask:0xf
    v_cndmask_b32_dpp v207, v107, v203, vcc row_ror:8 row_mask:0xf bank_mask:0xf
    v_pk_max_i16 v205, v205, 0
    v_pk_max_i16 v206, v206, 0
    v_pk_max_i16 v207, v207, 0
    v_mov_b32_dpp v104, v200 row_ror:8 row_mask:0xf bank_mask:0x3
    v_mov_b32_dpp v105, v201 row_ror:8 row_mask:0xf bank_mask:0x3
    v_mov_b32_dpp v106, v202 row_ror:8 row_mask:0xf bank_mask:0x3
    v_mov_b32_dpp v107, v203 row_ror:8 row_mask:0xf bank_mask:0x3
    buffer_store_dwordx4 v[204:207], v246, s[12:15], s34 offen offset:0 sc0 sc1
    v_pk_max_i16 v104, v104, 0
    v_pk_max_i16 v105, v105, 0
    v_pk_max_i16 v106, v106, 0
    v_pk_max_i16 v107, v107, 0
    buffer_store_dwordx4 v[104:107], v246, s[12:15], s34 offen offset:2048 sc0 sc1
    s_barrier
    s_and_b32 s40, s40, 0xff
    s_cbranch_scc1 L_slow
    s_endpgm
L_slow:
    s_waitcnt vmcnt(0)
    s_mul_i32 s36, s3, 40960
    s_lshl_b32 s44, s2, 1
    s_add_u32 s44, s44, s5
    s_mul_i32 s35, s44, 1
    s_add_u32 s35, s35, 3584
    s_mov_b32 s46, 0xffff
    s_mov_b32 s47, 0
    v_mov_b32 v139, 0xff800000
    s_mul_i32 s44, s5, 26112
    s_add_u32 s44, s44, 0
    s_sub_u32 s44, s36, s44
    v_add_u32 v245, s44, v245
    s_mov_b32 s10, 25600
    s_mov_b32 s14, 25600
L_slow_next:
    s_ff1_i32_b32 s44, s40
    s_bitset0_b32 s40, s44
    s_mul_i32 s44, s44, 512
    s_sub_u32 s44, s35, s44
    s_mul_i32 s44, s44, 25600
    s_add_u32 s8, s16, s44
    s_addc_u32 s9, s17, 0
    s_add_u32 s12, s26, s44
    s_addc_u32 s13, s27, 0
    s_mov_b32 m0, s36
    s_mov_b32 s37, 0
L_slow_dma:
    buffer_load_dwordx4 v248, s[8:11], s37 offen lds
    s_add_u32 m0, m0, 1088
    s_add_u32 s37, s37, 1024
    s_cmp_lt_u32 s37, 28672
    s_cbranch_scc1 L_slow_dma
    v_mov_b32 v140, v245
    s_mov_b32 s33, 0
    s_waitcnt vmcnt(0)
    ds_read_b128 v[120:123], v140 offset:0
    ds_read_b128 v[124:127], v140 offset:64
    ds_read_b128 v[128:131], v140 offset:128
    ds_read_b128 v[132:135], v140 offset:192
    v_mov_b32 v106, 0
    v_mov_b32 v107, 0
    v_mov_b32 v110, 0
    v_mov_b32 v111, 0
    v_mov_b32 v114, 0
    v_mov_b32 v115, 0
    v_mov_b32 v118, 0
    v_mov_b32 v119, 0
    s_waitcnt lgkmcnt(0)
    v_mfma_f32_16x16x32_bf16 v[232:235], a[0:3], v[120:123], 0
    v_mfma_f32_16x16x32_bf16 v[232:235], a[4:7], v[124:127], v[232:235]
    v_mfma_f32_16x16x32_bf16 v[232:235], a[8:11], v[128:131], v[232:235]
    v_mfma_f32_16x16x32_bf16 v[232:235], a[12:15], v[132:135], v[232:235]
    s_nop 1
    v_mfma_f32_16x16x32_bf16 v[236:239], a[28:31], v[132:135], 0
    s_nop 2
    v_mfma_f32_16x16x32_bf16 v[236:239], a[24:27], v[128:131], v[236:239]
    s_nop 0
    v_cvt_pk_bf16_f32 v0, v232, v233
    v_cvt_pk_bf16_f32 v1, v234, v235
    v_mfma_f32_16x16x32_bf16 v[236:239], a[20:23], v[124:127], v[236:239]
    v_mfma_f32_16x16x32_bf16 v[236:239], a[16:19], v[120:123], v[236:239]
    s_nop 1
    v_mfma_f32_16x16x32_bf16 v[240:243], a[32:35], v[120:123], 0
    s_nop 2
    v_mfma_f32_16x16x32_bf16 v[240:243], a[36:39], v[124:127], v[240:243]
    s_nop 0
    v_cvt_pk_bf16_f32 v2, v236, v237
    v_cvt_pk_bf16_f32 v3, v238, v239
    v_mfma_f32_16x16x32_bf16 v[240:243], a[40:43], v[128:131], v[240:243]
    v_mfma_f32_16x16x32_bf16 v[240:243], a[44:47], v[132:135], v[240:243]
    s_nop 1
    v_mfma_f32_16x16x32_bf16 v[232:235], a[60:63], v[132:135], 0
    s_nop 2
    v_mfma_f32_16x16x32_bf16 v[232:235], a[56:59], v[128:131], v[232:235]
    s_nop 0
    v_cvt_pk_bf16_f32 v4, v240, v241
    v_cvt_pk_bf16_f32 v5, v242, v243
    v_mfma_f32_16x16x32_bf16 v[232:235], a[52:55], v[124:127], v[232:235]
    v_mfma_f32_16x16x32_bf16 v[232:235], a[48:51], v[120:123], v[232:235]
    s_nop 1
    v_mfma_f32_16x16x32_bf16 v[236:239], v[120:123], a[64:67], 0
    s_nop 2
    v_mfma_f32_16x16x32_bf16 v[236:239], v[124:127], a[68:71], v[236:239]
    s_nop 0
    v_cvt_pk_bf16_f32 v6, v232, v233
    v_cvt_pk_bf16_f32 v7, v234, v235
    v_mfma_f32_16x16x32_bf16 v[236:239], v[128:131], a[72:75], v[236:239]
    v_mfma_f32_16x16x32_bf16 v[236:239], v[132:135], a[76:79], v[236:239]
    s_nop 1
    v_mfma_f32_16x16x32_bf16 v[240:243], v[132:135], a[92:95], 0
    s_nop 2
    v_mfma_f32_16x16x32_bf16 v[240:243], v[128:131], a[88:91], v[240:243]
    s_nop 0
    v_cvt_pk_bf16_f32 v56, v236, v237
    v_cvt_pk_bf16_f32 v57, v238, v239
    v_mfma_f32_16x16x32_bf16 v[240:243], v[124:127], a[84:87], v[240:243]
    v_mfma_f32_16x16x32_bf16 v[240:243], v[120:123], a[80:83], v[240:243]
    s_nop 1
    v_mfma_f32_16x16x32_bf16 v[232:235], v[120:123], a[96:99], 0
    s_nop 2
    v_mfma_f32_16x16x32_bf16 v[232:235], v[124:127], a[100:103], v[232:235]
    s_nop 0
    v_cvt_pk_bf16_f32 v60, v240, v241
    v_cvt_pk_bf16_f32 v61, v242, v243
    v_mfma_f32_16x16x32_bf16 v[232:235], v[128:131], a[104:107], v[232:235]
    v_mfma_f32_16x16x32_bf16 v[232:235], v[132:135], a[108:111], v[232:235]
    s_nop 0
    v_mfma_f32_16x16x32_bf16 v[236:239], v[132:135], a[124:127], 0
    s_nop 0
    ds_read_b128 v[132:135], v140 offset:4544
    s_nop 0
    v_mfma_f32_16x16x32_bf16 v[236:239], v[128:131], a[120:123], v[236:239]
    s_nop 0
    ds_read_b128 v[128:131], v140 offset:4480
    v_cvt_pk_bf16_f32 v64, v232, v233
    v_mfma_f32_16x16x32_bf16 v[236:239], v[124:127], a[116:119], v[236:239]
    ds_read_b128 v[124:127], v140 offset:4416
    v_cvt_pk_bf16_f32 v65, v234, v235
    v_mfma_f32_16x16x32_bf16 v[236:239], v[120:123], a[112:115], v[236:239]
    s_nop 0
    ds_read_b128 v[120:123], v140 offset:4352
    s_nop 5
    v_cvt_pk_bf16_f32 v68, v236, v237
    v_cvt_pk_bf16_f32 v69, v238, v239
    s_waitcnt lgkmcnt(0)
    v_mfma_f32_16x16x32_bf16 v[240:243], a[0:3], v[120:123], 0
    v_mfma_f32_16x16x32_bf16 v[240:243], a[4:7], v[124:127], v[240:243]
    v_mfma_f32_16x16x32_bf16 v[240:243], a[8:11], v[128:131], v[240:243]
    v_mfma_f32_16x16x32_bf16 v[240:243], a[12:15], v[132:135], v[240:243]
    s_nop 1
    v_mfma_f32_16x16x32_bf16 v[232:235], a[28:31], v[132:135], 0
    s_nop 2
    v_mfma_f32_16x16x32_bf16 v[232:235], a[24:27], v[128:131], v[232:235]
    s_nop 0
    v_cvt_pk_bf16_f32 v8, v240, v241
    v_cvt_pk_bf16_f32 v9, v242, v243
    v_mfma_f32_16x16x32_bf16 v[232:235], a[20:23], v[124:127], v[232:235]
    v_mfma_f32_16x16x32_bf16 v[232:235], a[16:19], v[120:123], v[232:235]
    s_nop 1
    v_mfma_f32_16x16x32_bf16 v[236:239], a[32:35], v[120:123], 0
    s_nop 2
    v_mfma_f32_16x16x32_bf16 v[236:239], a[36:39], v[124:127], v[236:239]
    s_nop 0
    v_cvt_pk_bf16_f32 v10, v232, v233
    v_cvt_pk_bf16_f32 v11, v234, v235
    v_mfma_f32_16x16x32_bf16 v[236:239], a[40:43], v[128:131], v[236:239]
    v_mfma_f32_16x16x32_bf16 v[236:239], a[44:47], v[132:135], v[236:239]
    s_nop 1
    v_mfma_f32_16x16x32_bf16 v[240:243], a[60:63], v[132:135], 0
    s_nop 2
    v_mfma_f32_16x16x32_bf16 v[240:243], a[56:59], v[128:131], v[240:243]
    s_nop 0
    v_cvt_pk_bf16_f32 v12, v236, v237
    v_cvt_pk_bf16_f32 v13, v238, v239
    v_mfma_f32_16x16x32_bf16 v[240:243], a[52:55], v[124:127], v[240:243]
    v_mfma_f32_16x16x32_bf16 v[240:243], a[48:51], v[120:123], v[240:243]
    s_nop 1
    v_mfma_f32_16x16x32_bf16 v[232:235], v[120:123], a[64:67], 0
    s_nop 2
    v_mfma_f32_16x16x32_bf16 v[232:235], v[124:127], a[68:71], v[232:235]
    s_nop 0
    v_cvt_pk_bf16_f32 v14, v240, v241
    v_cvt_pk_bf16_f32 v15, v242, v243
    v_mfma_f32_16x16x32_bf16 v[232:235], v[128:131], a[72:75], v[232:235]
    v_mfma_f32_16x16x32_bf16 v[232:235], v[132:135], a[76:79], v[232:235]
    s_nop 1
    v_mfma_f32_16x16x32_bf16 v[236:239], v[132:135], a[92:95], 0
    s_nop 2
    v_mfma_f32_16x16x32_bf16 v[236:239], v[128:131], a[88:91], v[236:239]
    s_nop 0
    v_cvt_pk_bf16_f32 v58, v232, v233
    v_cvt_pk_bf16_f32 v59, v234, v235
    v_mfma_f32_16x16x32_bf16 v[236:239], v[124:127], a[84:87], v[236:239]
    v_mfma_f32_16x16x32_bf16 v[236:239], v[120:123], a[80:83], v[236:239]
    s_nop 1
    v_mfma_f32_16x16x32_bf16 v[240:243], v[120:123], a[96:99], 0
    s_nop 2
    v_mfma_f32_16x16x32_bf16 v[240:243], v[124:127], a[100:103], v[240:243]
    s_nop 0
    v_cvt_pk_bf16_f32 v62, v236, v237
    v_cvt_pk_bf16_f32 v63, v238, v239
    v_mfma_f32_16x16x32_bf16 v[240:243], v[128:131], a[104:107], v[240:243]
    v_mfma_f32_16x16x32_bf16 v[240:243], v[132:135], a[108:111], v[240:243]
    s_nop 0
    v_mfma_f32_16x16x32_bf16 v[232:235], v[132:135], a[124:127], 0
    s_nop 0
    ds_read_b128 v[132:135], v140 offset:8896
    s_nop 0
    v_mfma_f32_16x16x32_bf16 v[232:235], v[128:131], a[120:123], v[232:235]
    s_nop 0
    ds_read_b128 v[128:131], v140 offset:8832
    v_cvt_pk_bf16_f32 v66, v240, v241
    v_mfma_f32_16x16x32_bf16 v[232:235], v[124:127], a[116:119], v[232:235]
    ds_read_b128 v[124:127], v140 offset:8768
    v_cvt_pk_bf16_f32 v67, v242, v243
    v_mfma_f32_16x16x32_bf16 v[232:235], v[120:123], a[112:115], v[232:235]
    s_nop 0
    ds_read_b128 v[120:123], v140 offset:8704
    s_nop 5
    v_cvt_pk_bf16_f32 v70, v232, v233
    v_cvt_pk_bf16_f32 v71, v234, v235
    s_waitcnt lgkmcnt(0)
    v_mfma_f32_16x16x32_bf16 v[236:239], a[0:3], v[120:123], 0
    v_mfma_f32_16x16x32_bf16 v[236:239], a[4:7], v[124:127], v[236:239]
    v_mfma_f32_16x16x32_bf16 v[236:239], a[8:11], v[128:131], v[236:239]
    v_mfma_f32_16x16x32_bf16 v[236:239], a[12:15], v[132:135], v[236:239]
    s_nop 1
    v_mfma_f32_16x16x32_bf16 v[240:243], a[28:31], v[132:135], 0
    s_nop 2
    v_mfma_f32_16x16x32_bf16 v[240:243], a[24:27], v[128:131], v[240:243]
    s_nop 0
    v_cvt_pk_bf16_f32 v16, v236, v237
    v_cvt_pk_bf16_f32 v17, v238, v239
    v_mfma_f32_16x16x32_bf16 v[240:243], a[20:23], v[124:127], v[240:243]
    v_mfma_f32_16x16x32_bf16 v[240:243], a[16:19], v[120:123], v[240:243]
    s_nop 1
    v_mfma_f32_16x16x32_bf16 v[232:235], a[32:35], v[120:123], 0
    s_nop 2
    v_mfma_f32_16x16x32_bf16 v[232:235], a[36:39], v[124:127], v[232:235]
    s_nop 0
    v_cvt_pk_bf16_f32 v18, v240, v241
    v_cvt_pk_bf16_f32 v19, v242, v243
    v_mfma_f32_16x16x32_bf16 v[232:235], a[40:43], v[128:131], v[232:235]
    v_mfma_f32_16x16x32_bf16 v[232:235], a[44:47], v[132:135], v[232:235]
    s_nop 1
    v_mfma_f32_16x16x32_bf16 v[236:239], a[60:63], v[132:135], 0
    s_nop 2
    v_mfma_f32_16x16x32_bf16 v[236:239], a[56:59], v[128:131], v[236:239]
    s_nop 0
    v_cvt_pk_bf16_f32 v20, v232, v233
    v_cvt_pk_bf16_f32 v21, v234, v235
    v_mfma_f32_16x16x32_bf16 v[236:239], a[52:55], v[124:127], v[236:239]
    v_mfma_f32_16x16x32_bf16 v[236:239], a[48:51], v[120:123], v[236:239]
    s_nop 1
    v_mfma_f32_16x16x32_bf16 v[240:243], v[120:123], a[64:67], 0
    s_nop 2
    v_mfma_f32_16x16x32_bf16 v[240:243], v[124:127], a[68:71], v[240:243]
    s_nop 0
    v_cvt_pk_bf16_f32 v22, v236, v237
    v_cvt_pk_bf16_f32 v23, v238, v239
    v_mfma_f32_16x16x32_bf16 v[240:243], v[128:131], a[72:75], v[240:243]
    v_mfma_f32_16x16x32_bf16 v[240:243], v[132:135], a[76:79], v[240:243]
    s_nop 1
    v_mfma_f32_16x16x32_bf16 v[232:235], v[132:135], a[92:95], 0
    s_nop 2
    v_mfma_f32_16x16x32_bf16 v[232:235], v[128:131], a[88:91], v[232:235]
    s_nop 0
    v_cvt_pk_bf16_f32 v72, v240, v241
    v_cvt_pk_bf16_f32 v73, v242, v243
    v_mfma_f32_16x16x32_bf16 v[232:235], v[124:127], a[84:87], v[232:235]
    v_mfma_f32_16x16x32_bf16 v[232:235], v[120:123], a[80:83], v[232:235]
    s_nop 1
    v_mfma_f32_16x16x32_bf16 v[236:239], v[120:123], a[96:99], 0
    s_nop 2
    v_mfma_f32_16x16x32_bf16 v[236:239], v[124:127], a[100:103], v[236:239]
    s_nop 0
    v_cvt_pk_bf16_f32 v76, v232, v233
    v_cvt_pk_bf16_f32 v77, v234, v235
    v_mfma_f32_16x16x32_bf16 v[236:239], v[128:131], a[104:107], v[236:239]
    v_mfma_f32_16x16x32_bf16 v[236:239], v[132:135], a[108:111], v[236:239]
    s_nop 0
    v_mfma_f32_16x16x32_bf16 v[240:243], v[132:135], a[124:127], 0
    s_nop 0
    ds_read_b128 v[132:135], v140 offset:13248
    s_nop 0
    v_mfma_f32_16x16x32_bf16 v[240:243], v[128:131], a[120:123], v[240:243]
    s_nop 0
    ds_read_b128 v[128:131], v140 offset:13184
    v_cvt_pk_bf16_f32 v80, v236, v237
    v_mfma_f32_16x16x32_bf16 v[240:243], v[124:127], a[116:119], v[240:243]
    ds_read_b128 v[124:127], v140 offset:13120
    v_cvt_pk_bf16_f32 v81, v238, v239
    v_mfma_f32_16x16x32_bf16 v[240:243], v[120:123], a[112:115], v[240:243]
    s_nop 0
    ds_read_b128 v[120:123], v140 offset:13056
    s_nop 5
    v_cvt_pk_bf16_f32 v84, v240, v241
    v_cvt_pk_bf16_f32 v85, v242, v243
    s_waitcnt lgkmcnt(0)
    v_mfma_f32_16x16x32_bf16 v[232:235], a[0:3], v[120:123], 0
    v_mfma_f32_16x16x32_bf16 v[232:235], a[4:7], v[124:127], v[232:235]
    v_mfma_f32_16x16x32_bf16 v[232:235], a[8:11], v[128:131], v[232:235]
    v_mfma_f32_16x16x32_bf16 v[232:235], a[12:15], v[132:135], v[232:235]
    s_nop 1
    v_mfma_f32_16x16x32_bf16 v[236:239], a[28:31], v[132:135], 0
    s_nop 2
    v_mfma_f32_16x16x32_bf16 v[236:239], a[24:27], v[128:131], v[236:239]
    s_nop 0
    v_cvt_pk_bf16_f32 v24, v232, v233
    v_cvt_pk_bf16_f32 v25, v234, v235
    v_mfma_f32_16x16x32_bf16 v[236:239], a[20:23], v[124:127], v[236:239]
    v_mfma_f32_16x16x32_bf16 v[236:239], a[16:19], v[120:123], v[236:239]
    s_nop 1
    v_mfma_f32_16x16x32_bf16 v[240:243], a[32:35], v[120:123], 0
    s_nop 2
    v_mfma_f32_16x16x32_bf16 v[240:243], a[36:39], v[124:127], v[240:243]
    s_nop 0
    v_cvt_pk_bf16_f32 v26, v236, v237
    v_cvt_pk_bf16_f32 v27, v238, v239
    v_mfma_f32_16x16x32_bf16 v[240:243], a[40:43], v[128:131], v[240:243]
    v_mfma_f32_16x16x32_bf16 v[240:243], a[44:47], v[132:135], v[240:243]
    s_nop 1
    v_mfma_f32_16x16x32_bf16 v[232:235], a[60:63], v[132:135], 0
    s_nop 2
    v_mfma_f32_16x16x32_bf16 v[232:235], a[56:59], v[128:131], v[232:235]
    s_nop 0
    v_cvt_pk_bf16_f32 v28, v240, v241
    v_cvt_pk_bf16_f32 v29, v242, v243
    v_mfma_f32_16x16x32_bf16 v[232:235], a[52:55], v[124:127], v[232:235]
    v_mfma_f32_16x16x32_bf16 v[232:235], a[48:51], v[120:123], v[232:235]
    s_nop 1
    v_mfma_f32_16x16x32_bf16 v[236:239], v[120:123], a[64:67], 0
    s_nop 2
    v_mfma_f32_16x16x32_bf16 v[236:239], v[124:127], a[68:71], v[236:239]
    s_nop 0
    v_cvt_pk_bf16_f32 v30, v232, v233
    v_cvt_pk_bf16_f32 v31, v234, v235
    v_mfma_f32_16x16x32_bf16 v[236:239], v[128:131], a[72:75], v[236:239]
    v_mfma_f32_16x16x32_bf16 v[236:239], v[132:135], a[76:79], v[236:239]
    s_nop 1
    v_mfma_f32_16x16x32_bf16 v[240:243], v[132:135], a[92:95], 0
    s_nop 2
    v_mfma_f32_16x16x32_bf16 v[240:243], v[128:131], a[88:91], v[240:243]
    s_nop 0
    v_cvt_pk_bf16_f32 v74, v236, v237
    v_cvt_pk_bf16_f32 v75, v238, v239
    v_mfma_f32_16x16x32_bf16 v[240:243], v[124:127], a[84:87], v[240:243]
    v_mfma_f32_16x16x32_bf16 v[240:243], v[120:123], a[80:83], v[240:243]
    s_nop 1
    v_mfma_f32_16x16x32_bf16 v[232:235], v[120:123], a[96:99], 0
    s_nop 2
    v_mfma_f32_16x16x32_bf16 v[232:235], v[124:127], a[100:103], v[232:235]
    s_nop 0
    v_cvt_pk_bf16_f32 v78, v240, v241
    v_cvt_pk_bf16_f32 v79, v242, v243
    v_mfma_f32_16x16x32_bf16 v[232:235], v[128:131], a[104:107], v[232:235]
    v_mfma_f32_16x16x32_bf16 v[232:235], v[132:135], a[108:111], v[232:235]
    s_nop 0
    v_mfma_f32_16x16x32_bf16 v[236:239], v[132:135], a[124:127], 0
    s_nop 0
    ds_read_b128 v[132:135], v140 offset:17600
    s_nop 0
    v_mfma_f32_16x16x32_bf16 v[236:239], v[128:131], a[120:123], v[236:239]
    s_nop 0
    ds_read_b128 v[128:131], v140 offset:17536
    v_cvt_pk_bf16_f32 v82, v232, v233
    v_mfma_f32_16x16x32_bf16 v[236:239], v[124:127], a[116:119], v[236:239]
    ds_read_b128 v[124:127], v140 offset:17472
    v_cvt_pk_bf16_f32 v83, v234, v235
    v_mfma_f32_16x16x32_bf16 v[236:239], v[120:123], a[112:115], v[236:239]
    s_nop 0
    ds_read_b128 v[120:123], v140 offset:17408
    s_nop 5
    v_cvt_pk_bf16_f32 v86, v236, v237
    v_cvt_pk_bf16_f32 v87, v238, v239
    s_waitcnt lgkmcnt(0)
    v_mfma_f32_16x16x32_bf16 v[240:243], a[0:3], v[120:123], 0
    v_mfma_f32_16x16x32_bf16 v[240:243], a[4:7], v[124:127], v[240:243]
    v_mfma_f32_16x16x32_bf16 v[240:243], a[8:11], v[128:131], v[240:243]
    v_mfma_f32_16x16x32_bf16 v[240:243], a[12:15], v[132:135], v[240:243]
    s_nop 1
    v_mfma_f32_16x16x32_bf16 v[232:235], a[28:31], v[132:135], 0
    s_nop 2
    v_mfma_f32_16x16x32_bf16 v[232:235], a[24:27], v[128:131], v[232:235]
    s_nop 0
    v_cvt_pk_bf16_f32 v32, v240, v241
    v_cvt_pk_bf16_f32 v33, v242, v243
    v_mfma_f32_16x16x32_bf16 v[232:235], a[20:23], v[124:127], v[232:235]
    v_mfma_f32_16x16x32_bf16 v[232:235], a[16:19], v[120:123], v[232:235]
    s_nop 1
    v_mfma_f32_16x16x32_bf16 v[236:239], a[32:35], v[120:123], 0
    s_nop 2
    v_mfma_f32_16x16x32_bf16 v[236:239], a[36:39], v[124:127], v[236:239]
    s_nop 0
    v_cvt_pk_bf16_f32 v34, v232, v233
    v_cvt_pk_bf16_f32 v35, v234, v235
    v_mfma_f32_16x16x32_bf16 v[236:239], a[40:43], v[128:131], v[236:239]
    v_mfma_f32_16x16x32_bf16 v[236:239], a[44:47], v[132:135], v[236:239]
    s_nop 1
    v_mfma_f32_16x16x32_bf16 v[240:243], a[60:63], v[132:135], 0
    s_nop 2
    v_mfma_f32_16x16x32_bf16 v[240:243], a[56:59], v[128:131], v[240:243]
    s_nop 0
    v_cvt_pk_bf16_f32 v36, v236, v237
    v_cvt_pk_bf16_f32 v37, v238, v239
    v_mfma_f32_16x16x32_bf16 v[240:243], a[52:55], v[124:127], v[240:243]
    v_mfma_f32_16x16x32_bf16 v[240:243], a[48:51], v[120:123], v[240:243]
    s_nop 1
    v_mfma_f32_16x16x32_bf16 v[232:235], v[120:123], a[64:67], 0
    s_nop 2
    v_mfma_f32_16x16x32_bf16 v[232:235], v[124:127], a[68:71], v[232:235]
    s_nop 0
    v_cvt_pk_bf16_f32 v38, v240, v241
    v_cvt_pk_bf16_f32 v39, v242, v243
    v_mfma_f32_16x16x32_bf16 v[232:235], v[128:131], a[72:75], v[232:235]
    v_mfma_f32_16x16x32_bf16 v[232:235], v[132:135], a[76:79], v[232:235]
    s_nop 1
    v_mfma_f32_16x16x32_bf16 v[236:239], v[132:135], a[92:95], 0
    s_nop 2
    v_mfma_f32_16x16x32_bf16 v[236:239], v[128:131], a[88:91], v[236:239]
    s_nop 0
    v_cvt_pk_bf16_f32 v88, v232, v233
    v_cvt_pk_bf16_f32 v89, v234, v235
    v_mfma_f32_16x16x32_bf16 v[236:239], v[124:127], a[84:87], v[236:239]
    v_mfma_f32_16x16x32_bf16 v[236:239], v[120:123], a[80:83], v[236:239]
    s_nop 1
    v_mfma_f32_16x16x32_bf16 v[240:243], v[120:123], a[96:99], 0
    s_nop 2
    v_mfma_f32_16x16x32_bf16 v[240:243], v[124:127], a[100:103], v[240:243]
    s_nop 0
    v_cvt_pk_bf16_f32 v92, v236, v237
    v_cvt_pk_bf16_f32 v93, v238, v239
    v_mfma_f32_16x16x32_bf16 v[240:243], v[128:131], a[104:107], v[240:243]
    v_mfma_f32_16x16x32_bf16 v[240:243], v[132:135], a[108:111], v[240:243]
    s_nop 0
    v_mfma_f32_16x16x32_bf16 v[232:235], v[132:135], a[124:127], 0
    s_nop 0
    ds_read_b128 v[132:135], v140 offset:21952
    s_nop 0
    v_mfma_f32_16x16x32_bf16 v[232:235], v[128:131], a[120:123], v[232:235]
    s_nop 0
    ds_read_b128 v[128:131], v140 offset:21888
    v_cvt_pk_bf16_f32 v96, v240, v241
    v_mfma_f32_16x16x32_bf16 v[232:235], v[124:127], a[116:119], v[232:235]
    ds_read_b128 v[124:127], v140 offset:21824
    v_cvt_pk_bf16_f32 v97, v242, v243
    v_mfma_f32_16x16x32_bf16 v[232:235], v[120:123], a[112:115], v[232:235]
    s_nop 0
    ds_read_b128 v[120:123], v140 offset:21760
    s_nop 5
    v_cvt_pk_bf16_f32 v100, v232, v233
    v_cvt_pk_bf16_f32 v101, v234, v235
    s_waitcnt lgkmcnt(0)
    v_mfma_f32_16x16x32_bf16 v[236:239], a[0:3], v[120:123], 0
    v_mfma_f32_16x16x32_bf16 v[236:239], a[4:7], v[124:127], v[236:239]
    v_mfma_f32_16x16x32_bf16 v[236:239], a[8:11], v[128:131], v[236:239]
    v_mfma_f32_16x16x32_bf16 v[236:239], a[12:15], v[132:135], v[236:239]
    s_nop 1
    v_mfma_f32_16x16x32_bf16 v[240:243], a[28:31], v[132:135], 0
    s_nop 2
    v_mfma_f32_16x16x32_bf16 v[240:243], a[24:27], v[128:131], v[240:243]
    s_nop 0
    v_cvt_pk_bf16_f32 v40, v236, v237
    v_cvt_pk_bf16_f32 v41, v238, v239
    v_mfma_f32_16x16x32_bf16 v[240:243], a[20:23], v[124:127], v[240:243]
    v_mfma_f32_16x16x32_bf16 v[240:243], a[16:19], v[120:123], v[240:243]
    s_nop 1
    v_mfma_f32_16x16x32_bf16 v[232:235], a[32:35], v[120:123], 0
    s_nop 2
    v_mfma_f32_16x16x32_bf16 v[232:235], a[36:39], v[124:127], v[232:235]
    s_nop 0
    v_cvt_pk_bf16_f32 v42, v240, v241
    v_cvt_pk_bf16_f32 v43, v242, v243
    v_mfma_f32_16x16x32_bf16 v[232:235], a[40:43], v[128:131], v[232:235]
    v_mfma_f32_16x16x32_bf16 v[232:235], a[44:47], v[132:135], v[232:235]
    s_nop 1
    v_mfma_f32_16x16x32_bf16 v[236:239], a[60:63], v[132:135], 0
    s_nop 2
    v_mfma_f32_16x16x32_bf16 v[236:239], a[56:59], v[128:131], v[236:239]
    s_nop 0
    v_cvt_pk_bf16_f32 v44, v232, v233
    v_cvt_pk_bf16_f32 v45, v234, v235
    v_mfma_f32_16x16x32_bf16 v[236:239], a[52:55], v[124:127], v[236:239]
    v_mfma_f32_16x16x32_bf16 v[236:239], a[48:51], v[120:123], v[236:239]
    s_nop 1
    v_mfma_f32_16x16x32_bf16 v[240:243], v[120:123], a[64:67], 0
    s_nop 2
    v_mfma_f32_16x16x32_bf16 v[240:243], v[124:127], a[68:71], v[240:243]
    s_nop 0
    v_cvt_pk_bf16_f32 v46, v236, v237
    v_cvt_pk_bf16_f32 v47, v238, v239
    v_mfma_f32_16x16x32_bf16 v[240:243], v[128:131], a[72:75], v[240:243]
    v_mfma_f32_16x16x32_bf16 v[240:243], v[132:135], a[76:79], v[240:243]
    s_nop 1
    v_mfma_f32_16x16x32_bf16 v[232:235], v[132:135], a[92:95], 0
    s_nop 2
    v_mfma_f32_16x16x32_bf16 v[232:235], v[128:131], a[88:91], v[232:235]
    s_nop 0
    v_cvt_pk_bf16_f32 v90, v240, v241
    v_cvt_pk_bf16_f32 v91, v242, v243
    v_mfma_f32_16x16x32_bf16 v[232:235], v[124:127], a[84:87], v[232:235]
    v_mfma_f32_16x16x32_bf16 v[232:235], v[120:123], a[80:83], v[232:235]
    s_nop 1
    v_mfma_f32_16x16x32_bf16 v[236:239], v[120:123], a[96:99], 0
    s_nop 2
    v_mfma_f32_16x16x32_bf16 v[236:239], v[124:127], a[100:103], v[236:239]
    s_nop 0
    v_cvt_pk_bf16_f32 v94, v232, v233
    v_cvt_pk_bf16_f32 v95, v234, v235
    v_mfma_f32_16x16x32_bf16 v[236:239], v[128:131], a[104:107], v[236:239]
    v_mfma_f32_16x16x32_bf16 v[236:239], v[132:135], a[108:111], v[236:239]
    s_nop 0
    v_mfma_f32_16x16x32_bf16 v[240:243], v[132:135], a[124:127], 0
    s_nop 0
    ds_read_b128 v[132:135], v140 offset:26304
    s_nop 0
    v_mfma_f32_16x16x32_bf16 v[240:243], v[128:131], a[120:123], v[240:243]
    s_nop 0
    ds_read_b128 v[128:131], v140 offset:26240
    v_cvt_pk_bf16_f32 v98, v236, v237
    v_mfma_f32_16x16x32_bf16 v[240:243], v[124:127], a[116:119], v[240:243]
    ds_read_b128 v[124:127], v140 offset:26176
    v_cvt_pk_bf16_f32 v99, v238, v239
    v_mfma_f32_16x16x32_bf16 v[240:243], v[120:123], a[112:115], v[240:243]
    s_nop 0
    ds_read_b128 v[120:123], v140 offset:26112
    s_nop 5
    v_cvt_pk_bf16_f32 v102, v240, v241
    v_cvt_pk_bf16_f32 v103, v242, v243
    s_waitcnt lgkmcnt(0)
    v_mfma_f32_16x16x32_bf16 v[232:235], a[0:3], v[120:123], 0
    v_mfma_f32_16x16x32_bf16 v[232:235], a[4:7], v[124:127], v[232:235]
    v_mfma_f32_16x16x32_bf16 v[232:235], a[8:11], v[128:131], v[232:235]
    v_mfma_f32_16x16x32_bf16 v[232:235], a[12:15], v[132:135], v[232:235]
    s_nop 1
    v_mfma_f32_16x16x32_bf16 v[236:239], a[28:31], v[132:135], 0
    s_nop 2
    v_mfma_f32_16x16x32_bf16 v[236:239], a[24:27], v[128:131], v[236:239]
    s_nop 0
    v_cvt_pk_bf16_f32 v48, v232, v233
    v_cvt_pk_bf16_f32 v49, v234, v235
    v_mfma_f32_16x16x32_bf16 v[236:239], a[20:23], v[124:127], v[236:239]
    v_mfma_f32_16x16x32_bf16 v[236:239], a[16:19], v[120:123], v[236:239]
    s_nop 1
    v_mfma_f32_16x16x32_bf16 v[240:243], a[32:35], v[120:123], 0
    s_nop 2
    v_mfma_f32_16x16x32_bf16 v[240:243], a[36:39], v[124:127], v[240:243]
    s_nop 0
    v_cvt_pk_bf16_f32 v50, v236, v237
    v_cvt_pk_bf16_f32 v51, v238, v239
    v_mfma_f32_16x16x32_bf16 v[240:243], a[40:43], v[128:131], v[240:243]
    v_mfma_f32_16x16x32_bf16 v[240:243], a[44:47], v[132:135], v[240:243]
    s_nop 1
    v_mfma_f32_16x16x32_bf16 v[232:235], a[60:63], v[132:135], 0
    s_nop 2
    v_mfma_f32_16x16x32_bf16 v[232:235], a[56:59], v[128:131], v[232:235]
    s_nop 0
    v_cvt_pk_bf16_f32 v52, v240, v241
    v_cvt_pk_bf16_f32 v53, v242, v243
    v_mfma_f32_16x16x32_bf16 v[232:235], a[52:55], v[124:127], v[232:235]
    v_mfma_f32_16x16x32_bf16 v[232:235], a[48:51], v[120:123], v[232:235]
    s_nop 1
    v_mfma_f32_16x16x32_bf16 v[236:239], v[120:123], a[64:67], 0
    s_nop 2
    v_mfma_f32_16x16x32_bf16 v[236:239], v[124:127], a[68:71], v[236:239]
    s_nop 0
    v_cvt_pk_bf16_f32 v54, v232, v233
    v_cvt_pk_bf16_f32 v55, v234, v235
    v_mfma_f32_16x16x32_bf16 v[236:239], v[128:131], a[72:75], v[236:239]
    v_mfma_f32_16x16x32_bf16 v[236:239], v[132:135], a[76:79], v[236:239]
    s_nop 1
    v_mfma_f32_16x16x32_bf16 v[240:243], v[132:135], a[92:95], 0
    s_nop 2
    v_mfma_f32_16x16x32_bf16 v[240:243], v[128:131], a[88:91], v[240:243]
    s_nop 0
    v_cvt_pk_bf16_f32 v104, v236, v237
    v_cvt_pk_bf16_f32 v105, v238, v239
    v_mfma_f32_16x16x32_bf16 v[240:243], v[124:127], a[84:87], v[240:243]
    v_mfma_f32_16x16x32_bf16 v[240:243], v[120:123], a[80:83], v[240:243]
    s_nop 1
    v_mfma_f32_16x16x32_bf16 v[232:235], v[120:123], a[96:99], 0
    s_nop 2
    v_mfma_f32_16x16x32_bf16 v[232:235], v[124:127], a[100:103], v[232:235]
    s_nop 0
    v_cvt_pk_bf16_f32 v108, v240, v241
    v_cvt_pk_bf16_f32 v109, v242, v243
    v_mfma_f32_16x16x32_bf16 v[232:235], v[128:131], a[104:107], v[232:235]
    v_mfma_f32_16x16x32_bf16 v[232:235], v[132:135], a[108:111], v[232:235]
    s_nop 1
    v_mfma_f32_16x16x32_bf16 v[236:239], v[132:135], a[124:127], 0
    s_nop 2
    v_mfma_f32_16x16x32_bf16 v[236:239], v[128:131], a[120:123], v[236:239]
    s_nop 0
    v_cvt_pk_bf16_f32 v112, v232, v233
    v_cvt_pk_bf16_f32 v113, v234, v235
    v_mfma_f32_16x16x32_bf16 v[236:239], v[124:127], a[116:119], v[236:239]
    v_mfma_f32_16x16x32_bf16 v[236:239], v[120:123], a[112:115], v[236:239]
    s_nop 7
    v_cvt_pk_bf16_f32 v116, v236, v237
    v_cvt_pk_bf16_f32 v117, v238, v239
L_slow_q:
    ds_read_b128 v[120:123], v140 offset:0
    ds_read_b128 v[124:127], v140 offset:64
    ds_read_b128 v[128:131], v140 offset:128
    ds_read_b128 v[132:135], v140 offset:192
    s_add_u32 s34, s33, 0
    v_add_u32 v140, 4352, v140
    s_add_u32 s33, s33, 4096
    s_waitcnt lgkmcnt(0)
    v_mfma_f32_16x16x32_bf16 v[232:235], a[128:131], v[120:123], 0
    v_mfma_f32_16x16x32_bf16 v[232:235], a[132:135], v[124:127], v[232:235]
    v_mfma_f32_16x16x32_bf16 v[232:235], a[136:139], v[128:131], v[232:235]
    v_mfma_f32_16x16x32_bf16 v[232:235], a[140:143], v[132:135], v[232:235]
    s_nop 1
    v_mfma_f32_16x16x32_bf16 v[236:239], a[156:159], v[132:135], 0
    s_nop 2
    v_mfma_f32_16x16x32_bf16 v[236:239], a[152:155], v[128:131], v[236:239]
    s_nop 0
    v_cvt_pk_bf16_f32 v192, v232, v233
    v_cvt_pk_bf16_f32 v193, v234, v235
    v_mfma_f32_16x16x32_bf16 v[236:239], a[148:151], v[124:127], v[236:239]
    v_mfma_f32_16x16x32_bf16 v[236:239], a[144:147], v[120:123], v[236:239]
    s_nop 1
    v_mfma_f32_16x16x32_bf16 v[240:243], a[160:163], v[120:123], 0
    s_nop 2
    v_mfma_f32_16x16x32_bf16 v[240:243], a[164:167], v[124:127], v[240:243]
    s_nop 0
    v_cvt_pk_bf16_f32 v194, v236, v237
    v_cvt_pk_bf16_f32 v195, v238, v239
    v_mfma_f32_16x16x32_bf16 v[240:243], a[168:171], v[128:131], v[240:243]
    v_mfma_f32_16x16x32_bf16 v[240:243], a[172:175], v[132:135], v[240:243]
    s_nop 1
    v_mfma_f32_16x16x32_bf16 v[232:235], a[188:191], v[132:135], 0
    s_nop 2
    v_mfma_f32_16x16x32_bf16 v[232:235], a[184:187], v[128:131], v[232:235]
    s_nop 0
    v_cvt_pk_bf16_f32 v196, v240, v241
    v_cvt_pk_bf16_f32 v197, v242, v243
    v_mfma_f32_16x16x32_bf16 v[232:235], a[180:183], v[124:127], v[232:235]
    v_mfma_f32_16x16x32_bf16 v[232:235], a[176:179], v[120:123], v[232:235]
    s_nop 1
    v_mfma_f32_16x16x32_bf16 v[216:219], a[192:195], v[120:123], 0
    s_nop 2
    v_mfma_f32_16x16x32_bf16 v[216:219], a[196:199], v[124:127], v[216:219]
    s_nop 0
    v_cvt_pk_bf16_f32 v198, v232, v233
    v_cvt_pk_bf16_f32 v199, v234, v235
    v_mfma_f32_16x16x32_bf16 v[216:219], a[200:203], v[128:131], v[216:219]
    v_mfma_f32_16x16x32_bf16 v[216:219], a[204:207], v[132:135], v[216:219]
    v_mfma_f32_16x16x32_bf16 v[220:223], a[220:223], v[132:135], 0
    v_mfma_f32_16x16x32_bf16 v[220:223], a[216:219], v[128:131], v[220:223]
    v_mfma_f32_16x16x32_bf16 v[220:223], a[212:215], v[124:127], v[220:223]
    v_mfma_f32_16x16x32_bf16 v[220:223], a[208:211], v[120:123], v[220:223]
    v_mfma_f32_16x16x32_bf16 v[224:227], a[224:227], v[120:123], 0
    v_mfma_f32_16x16x32_bf16 v[224:227], a[228:231], v[124:127], v[224:227]
    v_mfma_f32_16x16x32_bf16 v[224:227], a[232:235], v[128:131], v[224:227]
    v_mfma_f32_16x16x32_bf16 v[224:227], a[236:239], v[132:135], v[224:227]
    v_mfma_f32_16x16x32_bf16 v[228:231], a[252:255], v[132:135], 0
    v_mfma_f32_16x16x32_bf16 v[228:231], a[248:251], v[128:131], v[228:231]
    v_mfma_f32_16x16x32_bf16 v[228:231], a[244:247], v[124:127], v[228:231]
    v_mfma_f32_16x16x32_bf16 v[228:231], a[240:243], v[120:123], v[228:231]
    v_mfma_f32_16x16x32_bf16 v[148:151], v[0:3], v[192:195], 0
    v_mfma_f32_16x16x32_bf16 v[148:151], v[4:7], v[196:199], v[148:151]
    s_nop 1
    v_mfma_f32_16x16x32_bf16 v[152:155], v[8:11], v[192:195], 0
    s_nop 2
    v_mfma_f32_16x16x32_bf16 v[152:155], v[12:15], v[196:199], v[152:155]
    s_nop 0
    v_max_f32 v136, v148, v149
    v_max3_f32 v136, v136, v150, v151
    v_mfma_f32_16x16x32_bf16 v[156:159], v[16:19], v[192:195], 0
    s_nop 1
    v_mfma_f32_16x16x32_bf16 v[156:159], v[20:23], v[196:199], v[156:159]
    s_nop 0
    v_max3_f32 v136, v136, v152, v153
    v_max3_f32 v136, v136, v154, v155
    v_mfma_f32_16x16x32_bf16 v[160:163], v[24:27], v[192:195], 0
    s_nop 1
    v_mfma_f32_16x16x32_bf16 v[160:163], v[28:31], v[196:199], v[160:163]
    s_nop 0
    v_max3_f32 v136, v136, v156, v157
    v_max3_f32 v136, v136, v158, v159
    v_mfma_f32_16x16x32_bf16 v[164:167], v[32:35], v[192:195], 0
    s_nop 1
    v_mfma_f32_16x16x32_bf16 v[164:167], v[36:39], v[196:199], v[164:167]
    s_nop 0
    v_max3_f32 v136, v136, v160, v161
    v_max3_f32 v136, v136, v162, v163
    v_mfma_f32_16x16x32_bf16 v[168:171], v[40:43], v[192:195], 0
    s_nop 1
    v_mfma_f32_16x16x32_bf16 v[168:171], v[44:47], v[196:199], v[168:171]
    s_nop 0
    v_max3_f32 v136, v136, v164, v165
    v_max3_f32 v136, v136, v166, v167
    v_mfma_f32_16x16x32_bf16 v[172:175], v[48:51], v[192:195], 0
    s_nop 1
    v_mfma_f32_16x16x32_bf16 v[172:175], v[52:55], v[196:199], v[172:175]
    s_nop 0
    v_max3_f32 v136, v136, v168, v169
    v_max3_f32 v136, v136, v170, v171
    s_nop 4
    v_cndmask_b32 v172, v139, v172, s[46:47]
    v_cndmask_b32 v173, v139, v173, s[46:47]
    v_cndmask_b32 v174, v139, v174, s[46:47]
    v_cndmask_b32 v175, v139, v175, s[46:47]
    v_max3_f32 v136, v136, v172, v173
    v_max3_f32 v136, v136, v174, v175
    v_mov_b32 v137, v136
    s_nop 1
    v_permlane16_swap_b32 v136, v137
    v_max_f32 v136, v136, v137
    v_mov_b32 v137, v136
    s_nop 1
    v_permlane32_swap_b32 v136, v137
    v_max_f32 v136, v136, v137
    v_sub_f32 v148, v148, v136
    v_sub_f32 v149, v149, v136
    v_sub_f32 v150, v150, v136
    v_sub_f32 v151, v151, v136
    v_sub_f32 v152, v152, v136
    v_sub_f32 v153, v153, v136
    v_sub_f32 v154, v154, v136
    v_sub_f32 v155, v155, v136
    v_exp_f32 v148, v148
    v_exp_f32 v149, v149
    v_exp_f32 v150, v150
    v_exp_f32 v151, v151
    v_exp_f32 v152, v152
    v_exp_f32 v153, v153
    v_exp_f32 v154, v154
    v_exp_f32 v155, v155
    v_sub_f32 v156, v156, v136
    v_sub_f32 v157, v157, v136
    v_sub_f32 v158, v158, v136
    v_sub_f32 v159, v159, v136
    v_sub_f32 v160, v160, v136
    v_sub_f32 v161, v161, v136
    v_sub_f32 v162, v162, v136
    v_sub_f32 v163, v163, v136
    v_cvt_pk_bf16_f32 v176, v148, v149
    v_cvt_pk_bf16_f32 v177, v150, v151
    v_cvt_pk_bf16_f32 v178, v152, v153
    v_cvt_pk_bf16_f32 v179, v154, v155
    v_exp_f32 v156, v156
    v_exp_f32 v157, v157
    v_mfma_f32_16x16x32_bf16 v[200:203], v[56:59], v[176:179], 0
    v_exp_f32 v158, v158
    v_exp_f32 v159, v159
    v_exp_f32 v160, v160
    v_exp_f32 v161, v161
    v_exp_f32 v162, v162
    v_exp_f32 v163, v163
    v_sub_f32 v164, v164, v136
    v_sub_f32 v165, v165, v136
    v_sub_f32 v166, v166, v136
    v_sub_f32 v167, v167, v136
    v_sub_f32 v168, v168, v136
    v_sub_f32 v169, v169, v136
    v_sub_f32 v170, v170, v136
    v_sub_f32 v171, v171, v136
    v_cvt_pk_bf16_f32 v180, v156, v157
    v_cvt_pk_bf16_f32 v181, v158, v159
    v_cvt_pk_bf16_f32 v182, v160, v161
    v_cvt_pk_bf16_f32 v183, v162, v163
    v_exp_f32 v164, v164
    v_exp_f32 v165, v165
    v_mfma_f32_16x16x32_bf16 v[200:203], v[72:75], v[180:183], v[200:203]
    v_exp_f32 v166, v166
    v_exp_f32 v167, v167
    v_exp_f32 v168, v168
    v_exp_f32 v169, v169
    v_exp_f32 v170, v170
    v_exp_f32 v171, v171
    v_sub_f32 v172, v172, v136
    v_sub_f32 v173, v173, v136
    v_sub_f32 v174, v174, v136
    v_sub_f32 v175, v175, v136
    v_cvt_pk_bf16_f32 v184, v164, v165
    v_cvt_pk_bf16_f32 v185, v166, v167
    v_cvt_pk_bf16_f32 v186, v168, v169
    v_cvt_pk_bf16_f32 v187, v170, v171
    v_exp_f32 v172, v172
    v_exp_f32 v173, v173
    v_mfma_f32_16x16x32_bf16 v[200:203], v[88:91], v[184:187], v[200:203]
    v_exp_f32 v174, v174
    v_exp_f32 v175, v175
    v_cvt_pk_bf16_f32 v188, v172, v173
    v_cvt_pk_bf16_f32 v189, v174, v175
    v_add_f32 v138, v148, v149
    v_add_f32 v138, v138, v150
    v_mfma_f32_16x16x32_bf16 v[200:203], v[104:107], v[188:191], v[200:203]
    v_add_f32 v138, v138, v151
    v_add_f32 v138, v138, v152
    v_mfma_f32_16x16x32_bf16 v[204:207], v[60:63], v[176:179], 0
    v_add_f32 v138, v138, v153
    v_add_f32 v138, v138, v154
    v_mfma_f32_16x16x32_bf16 v[204:207], v[76:79], v[180:183], v[204:207]
    v_add_f32 v138, v138, v155
    v_add_f32 v138, v138, v156
    v_mfma_f32_16x16x32_bf16 v[204:207], v[92:95], v[184:187], v[204:207]
    v_add_f32 v138, v138, v157
    v_add_f32 v138, v138, v158
    v_mfma_f32_16x16x32_bf16 v[204:207], v[108:111], v[188:191], v[204:207]
    v_add_f32 v138, v138, v159
    v_add_f32 v138, v138, v160
    v_mfma_f32_16x16x32_bf16 v[208:211], v[64:67], v[176:179], 0
    v_add_f32 v138, v138, v161
    v_add_f32 v138, v138, v162
    v_mfma_f32_16x16x32_bf16 v[208:211], v[80:83], v[180:183], v[208:211]
    v_add_f32 v138, v138, v163
    v_add_f32 v138, v138, v164
    v_mfma_f32_16x16x32_bf16 v[208:211], v[96:99], v[184:187], v[208:211]
    v_add_f32 v138, v138, v165
    v_add_f32 v138, v138, v166
    v_mfma_f32_16x16x32_bf16 v[208:211], v[112:115], v[188:191], v[208:211]
    v_add_f32 v138, v138, v167
    v_add_f32 v138, v138, v168
    v_mfma_f32_16x16x32_bf16 v[212:215], v[68:71], v[176:179], 0
    v_add_f32 v138, v138, v169
    v_add_f32 v138, v138, v170
    v_mfma_f32_16x16x32_bf16 v[212:215], v[84:87], v[180:183], v[212:215]
    v_add_f32 v138, v138, v171
    v_add_f32 v138, v138, v172
    v_mfma_f32_16x16x32_bf16 v[212:215], v[100:103], v[184:187], v[212:215]
    v_add_f32 v138, v138, v173
    v_add_f32 v138, v138, v174
    v_mfma_f32_16x16x32_bf16 v[212:215], v[116:119], v[188:191], v[212:215]
    v_add_f32 v138, v138, v175
    v_mov_b32 v137, v138
    s_nop 1
    v_permlane16_swap_b32 v138, v137
    v_add_f32 v138, v138, v137
    v_mov_b32 v137, v138
    s_nop 1
    v_permlane32_swap_b32 v138, v137
    v_add_f32 v138, v138, v137
    v_rcp_f32 v253, v138
    s_nop 0
    v_fma_f32 v200, v200, v253, v216
    v_fma_f32 v201, v201, v253, v217
    v_fma_f32 v208, v208, v253, v224
    v_fma_f32 v209, v209, v253, v225
    v_fma_f32 v202, v202, v253, v218
    v_fma_f32 v203, v203, v253, v219
    v_cvt_pk_bf16_f32 v200, v200, v201
    v_fma_f32 v210, v210, v253, v226
    v_fma_f32 v211, v211, v253, v227
    v_cvt_pk_bf16_f32 v208, v208, v209
    v_fma_f32 v204, v204, v253, v220
    v_fma_f32 v205, v205, v253, v221
    v_fma_f32 v206, v206, v253, v222
    v_fma_f32 v207, v207, v253, v223
    v_cvt_pk_bf16_f32 v201, v202, v203
    v_fma_f32 v212, v212, v253, v228
    v_fma_f32 v213, v213, v253, v229
    v_fma_f32 v214, v214, v253, v230
    v_fma_f32 v215, v215, v253, v231
    v_cvt_pk_bf16_f32 v209, v210, v211
    v_cvt_pk_bf16_f32 v202, v204, v205
    v_cvt_pk_bf16_f32 v203, v206, v207
    v_cvt_pk_bf16_f32 v210, v212, v213
    v_cvt_pk_bf16_f32 v211, v214, v215
    v_cndmask_b32_dpp v204, v208, v200, vcc row_ror:8 row_mask:0xf bank_mask:0xf
    v_cndmask_b32_dpp v205, v209, v201, vcc row_ror:8 row_mask:0xf bank_mask:0xf
    v_cndmask_b32_dpp v206, v210, v202, vcc row_ror:8 row_mask:0xf bank_mask:0xf
    v_cndmask_b32_dpp v207, v211, v203, vcc row_ror:8 row_mask:0xf bank_mask:0xf
    v_pk_max_i16 v204, v204, 0
    v_pk_max_i16 v205, v205, 0
    v_pk_max_i16 v206, v206, 0
    v_pk_max_i16 v207, v207, 0
    v_mov_b32_dpp v208, v200 row_ror:8 row_mask:0xf bank_mask:0x3
    v_mov_b32_dpp v209, v201 row_ror:8 row_mask:0xf bank_mask:0x3
    v_mov_b32_dpp v210, v202 row_ror:8 row_mask:0xf bank_mask:0x3
    v_mov_b32_dpp v211, v203 row_ror:8 row_mask:0xf bank_mask:0x3
    buffer_store_dwordx4 v[204:207], v246, s[12:15], s34 offen offset:0 sc0 sc1
    v_pk_max_i16 v208, v208, 0
    v_pk_max_i16 v209, v209, 0
    v_pk_max_i16 v210, v210, 0
    v_pk_max_i16 v211, v211, 0
    buffer_store_dwordx4 v[208:211], v246, s[12:15], s34 offen offset:2048 sc0 sc1
    s_nop 3
    s_cmp_lt_u32 s33, 28672
    s_cbranch_scc1 L_slow_q
    s_cmp_lg_u32 s40, 0
    s_cbranch_scc1 L_slow_next
L_end:
    s_endpgm
.section .rodata,"a"
.p2align 6
.amdhsa_kernel standalone__attention_interact_autoint__recsys_kernel
  .amdhsa_next_free_vgpr 512
  .amdhsa_next_free_sgpr 102
  .amdhsa_accum_offset 256
  .amdhsa_group_segment_fixed_size 0
  .amdhsa_kernarg_size 64
  .amdhsa_user_sgpr_count 2
  .amdhsa_user_sgpr_kernarg_segment_ptr 1
  .amdhsa_system_sgpr_workgroup_id_x 1
  .amdhsa_float_denorm_mode_32 3
.end_amdhsa_kernel
```
